```python
import torch

def _softmax(x, axis=-1):
    return torch.softmax(x, dim=axis)
def _gelu(x):
    return torch.nn.functional.gelu(x, approximate="tanh")
def _silu(x):
    return torch.nn.functional.silu(x)
def _sigmoid(x):
    return torch.sigmoid(x)
def _layernorm(x, axis=-1, eps=1e-5):
    m = x.mean(dim=axis, keepdim=True)
    v = x.var(dim=axis, keepdim=True, unbiased=False)
    return (x - m) / torch.sqrt(v + eps)
def _scatter_add(tgt, idx, src, axis=0):
    return tgt.clone().index_add_(axis, idx, src)
def _segment_sum(src, seg, n):
    out = torch.zeros((n,) + src.shape[1:], dtype=src.dtype)
    return out.index_add_(0, seg, src)
def _pad(x, pw):
    flat = tuple(v for pair in reversed(pw) for v in pair)
    return torch.nn.functional.pad(x, flat)

kernel_name = 'gated_mix__ssm_conv_s4__ssm_conv_s5__prompt'

def setup_inputs():

    _w = (lambda a: (lambda t: t.to(torch.bfloat16) if t.is_floating_point() else t)(torch.as_tensor(a)))
    def _A_setup():
        B, L, D, N = 1, 2048, 448, 256
        A_re = -(lambda _x: torch.exp(torch.as_tensor(_x)))((lambda *s: torch.randn(*s, dtype=torch.bfloat16) * 3.2)(D, N))
        A_im = torch.pi * (lambda *s: torch.randn(*s, dtype=torch.bfloat16) * 0.05)(D, N)
        B_re = (lambda *s: torch.randn(*s, dtype=torch.bfloat16) * 0.05)(D, N)
        B_im = (lambda *s: torch.randn(*s, dtype=torch.bfloat16) * 0.1)(D, N)
        C_re = (lambda *s: torch.randn(*s, dtype=torch.bfloat16) * 0.1)(D, N)
        C_im = (lambda *s: torch.randn(*s, dtype=torch.bfloat16) * 0.1)(D, N)
        log_dt = (lambda *s: torch.randn(*s, dtype=torch.bfloat16) * 0.05)(D) * 0.5 - 4.0
        Dskip = (lambda *s: torch.randn(*s, dtype=torch.bfloat16) * 0.05)(D)
        return {
            "u": _w((lambda *s: torch.randn(*s, dtype=torch.bfloat16) * 0.05)(B, L, D)),
            "A_re": _w(A_re),
            "A_im": _w(A_im),
            "B_re": _w(B_re),
            "B_im": _w(B_im),
            "C_re": _w(C_re),
            "C_im": _w(C_im),
            "log_dt": _w(log_dt),
            "Dskip": _w(Dskip),
        }
    _A_in = _A_setup()

    def _B_setup():
        B, S, D = 1, 2048, 448
        P = D
        Lambda_re = -0.5 * (lambda _x: torch.exp(torch.as_tensor(_x)))((lambda *s: torch.randn(*s, dtype=torch.bfloat16) * 0.2)(P))
        Lambda_im = (lambda *s: torch.randn(*s, dtype=torch.bfloat16) * 0.4)(P) * 1.0
        B_re = (lambda *s: torch.randn(*s, dtype=torch.bfloat16) * 0.2)(P, D) * (D ** -0.5)
        B_im = (lambda *s: torch.randn(*s, dtype=torch.bfloat16) * 0.2)(P, D) * (D ** -0.5)
        C_re = (lambda *s: torch.randn(*s, dtype=torch.bfloat16) * 0.2)(D, P) * (P ** -0.5)
        C_im = (lambda *s: torch.randn(*s, dtype=torch.bfloat16) * 0.2)(D, P) * (P ** -0.5)
        log_dt = (lambda *s: torch.randn(*s, dtype=torch.bfloat16) * 0.2)(P) * 0.3 - 2.0
        Dskip = (lambda *s: torch.randn(*s, dtype=torch.bfloat16) * 0.05)(D)
        return {
            "x": _w((lambda *s: torch.randn(*s, dtype=torch.bfloat16) * 0.05)(B, S, D)),
            "Lambda_re": _w(Lambda_re),
            "Lambda_im": _w(Lambda_im),
            "B_re": _w(B_re),
            "B_im": _w(B_im),
            "C_re": _w(C_re),
            "C_im": _w(C_im),
            "log_dt": _w(log_dt),
            "Dskip": _w(Dskip),
        }
    _B_in = _B_setup()

    return {
        "A_u": _A_in["u"],
        "A_A_re": _A_in["A_re"],
        "A_A_im": _A_in["A_im"],
        "A_B_re": _A_in["B_re"],
        "A_B_im": _A_in["B_im"],
        "A_C_re": _A_in["C_re"],
        "A_C_im": _A_in["C_im"],
        "A_log_dt": _A_in["log_dt"],
        "A_Dskip": _A_in["Dskip"],
        "B_x": _B_in["x"],
        "B_Lambda_re": _B_in["Lambda_re"],
        "B_Lambda_im": _B_in["Lambda_im"],
        "B_B_re": _B_in["B_re"],
        "B_B_im": _B_in["B_im"],
        "B_C_re": _B_in["C_re"],
        "B_C_im": _B_in["C_im"],
        "B_log_dt": _B_in["log_dt"],
        "B_Dskip": _B_in["Dskip"],
        "gate_w": _w((lambda *s: torch.randn(*s, dtype=torch.bfloat16) * 0.05)(448) * 16.0),
    }

def reference(A_u, A_A_re, A_A_im, A_B_re, A_B_im, A_C_re, A_C_im, A_log_dt, A_Dskip, B_x, B_Lambda_re, B_Lambda_im, B_B_re, B_B_im, B_C_re, B_C_im, B_log_dt, B_Dskip, gate_w):
    def _A_ref(u, A_re, A_im, B_re, B_im, C_re, C_im, log_dt, Dskip):
        Bsz, L, D = u.shape
        dt = torch.exp(log_dt)[:, None]
        A = A_re + 1j * A_im
        Bc = B_re + 1j * B_im
        Cc = C_re + 1j * C_im
        logdA = dt * A
        dB = dt * Bc
        l = (lambda x, dt: x.to(dt))(torch.arange(L), A_re.dtype)
        P = torch.exp(logdA[:, :, None] * l[None, None, :])
        K = torch.einsum("dn,dnl,dn->dl", Cc, P, dB).real
        L2 = 2 * L
        Kp = _pad(K, ((0, 0), (0, L)))
        up = (lambda x, *d: x.permute(*d))(u, 0, 2, 1)
        up = _pad(up, ((0, 0), (0, 0), (0, L)))
        Kf = (lambda x, axes=(-2,-1): torch.fft.rfft2(x.float(), dim=axes))(Kp[:, None, :], axes=(-2, -1))
        Uf = (lambda x, axes=(-2,-1): torch.fft.rfft2(x.float(), dim=axes))(up[:, :, None, :], axes=(-2, -1))
        Yf = Uf * Kf[None, :, :, :]
        y = (lambda x, s, axes=(-2,-1): torch.fft.irfft2(x, s=s, dim=axes).to(torch.bfloat16))(Yf, (1, L2), axes=(-2, -1))[:, :, 0, :L]
        y = (lambda x, *d: x.permute(*d))(y, 0, 2, 1) + u * Dskip[None, None, :]
        return y

    def _B_ref(x, Lambda_re, Lambda_im, B_re, B_im, C_re, C_im, log_dt, Dskip):
        Bsz, L, H = x.shape
        Lam = Lambda_re + 1j * Lambda_im
        Bmat = B_re + 1j * B_im
        Cmat = C_re + 1j * C_im
        dt = torch.exp(log_dt)
        Lam_bar = torch.exp(dt * Lam)
        B_bar = ((Lam_bar - 1.0) / Lam)[:, None] * Bmat
        Bu = torch.einsum("bld,pd->blp", x + 0j, B_bar)
        h = torch.zeros_like(Bu[:, 0, :])
        hs = []
        for t in range(L):
            h = Lam_bar[None, :] * h + Bu[:, t, :]
            hs.append(h)
        hseq = torch.stack(hs, 1)
        y = 2.0 * torch.einsum("blp,dp->bld", hseq, Cmat).real + x * Dskip[None, None, :]
        return y

    x = A_u
    g = _sigmoid((x * gate_w).sum(-1, keepdims=True))
    a = _A_ref(x, A_A_re, A_A_im, A_B_re, A_B_im, A_C_re, A_C_im, A_log_dt, A_Dskip)
    b = _B_ref(x, B_Lambda_re, B_Lambda_im, B_B_re, B_B_im, B_C_re, B_C_im, B_log_dt, B_Dskip)
    return g * a + (1 - g) * b
```

```asm
; @launch grid=(256,1,1) block=(512,1,1) lds=163840
.amdgcn_target "amdgcn-amd-amdhsa--gfx950"
.text
.globl gated_mix__ssm_conv_s4__ssm_conv_s5__prompt_kernel
.p2align 8
.type gated_mix__ssm_conv_s4__ssm_conv_s5__prompt_kernel,@function
gated_mix__ssm_conv_s4__ssm_conv_s5__prompt_kernel:
    s_getpc_b64 s[14:15]
    v_lshlrev_b32 v5, 6, v0
    s_load_dwordx16 s[16:31], s[0:1], 0
    v_min_u32 v5, LEND-gated_mix__ssm_conv_s4__ssm_conv_s5__prompt_kernel-8, v5
    s_cmp_ge_u32 s2, 256
    s_nop 0
    s_cbranch_scc1 LEND
    global_load_dword v8, v5, s[14:15]
    s_load_dwordx4 s[56:59], s[0:1], 160
    s_load_dwordx16 s[32:47], s[0:1], 64
    s_load_dwordx8 s[48:55], s[0:1], 128
    s_sub_u32 s7, s2, 32
    s_and_b32 s8, s7, 7
    s_lshr_b32 s7, s7, 3
    s_mul_i32 s4, s8, 28
    s_add_u32 s4, s4, s7
    s_lshl_b32 s7, s4, 10
    v_lshl_add_u32 v4, v0, 1, s7
    v_mov_b32 v10, 0
    v_mov_b32 v11, 0
    v_mov_b32 v12, 0
    v_mov_b32 v13, 0
    v_mov_b32 v14, 0
    v_mov_b32 v15, 0
    v_lshrrev_b32 v6, 6, v0
    v_and_b32 v1, 63, v0
    v_readfirstlane_b32 s3, v6
    s_mov_b32 s12, 12713984
    s_cmp_lt_u32 s2, 32
    s_nop 2
    s_cbranch_scc1 LGATE
    v_mov_b32 v18, 161792
    ds_write_b64 v18, v[10:11]
    s_lshl_b32 s7, s4, 2
    s_waitcnt lgkmcnt(0)
    global_load_short_d16_hi v10, v4, s[18:19]
    global_load_short_d16_hi v11, v4, s[20:21]
    global_load_short_d16_hi v12, v4, s[22:23]
    global_load_short_d16_hi v13, v4, s[24:25]
    global_load_short_d16_hi v14, v4, s[26:27]
    global_load_short_d16_hi v15, v4, s[28:29]
    s_load_dword s10, s[30:31], s7
    s_load_dword s11, s[58:59], s12
    v_and_b32 v2, 15, v0
    v_lshrrev_b32 v3, 4, v1
    s_mul_i32 s5, s4, 9363
    s_lshr_b32 s5, s5, 16
    s_mul_i32 s6, s5, 7
    s_sub_u32 s6, s4, s6
    v_mov_b32 v172, 0
    v_mov_b32 v173, 0
    v_mov_b32 v174, 0
    v_lshrrev_b32 v16, 3, v1
    v_and_b32 v9, 7, v1
    v_xor_b32 v17, v9, v16
    v_lshlrev_b32 v17, 4, v17
    v_lshrrev_b32 v5, 2, v16
    v_and_b32 v6, 3, v16
    v_lshl_add_u32 v5, v5, 4, v6
    s_and_b32 s7, s3, 1
    s_lshl_b32 s7, s7, 5
    s_lshr_b32 s8, s3, 1
    s_lshl_b32 s8, s8, 2
    s_add_u32 s7, s7, s8
    s_lshl_b32 s8, s5, 6
    s_add_u32 s7, s7, s8
    v_add_u32 v5, s7, v5
    s_movk_i32 s9, 896
    v_mad_u32_u24 v148, v5, s9, v17
    s_lshl_b32 s7, s6, 6
    s_lshl_b32 s8, s3, 3
    s_add_u32 s7, s7, s8
    v_add_u32 v5, s7, v16
    v_mad_u32_u24 v149, v5, s9, v17
    v_add_u32 v9, s7, v9
    v_lshlrev_b32 v9, 1, v9
    global_load_short_d16_hi v172, v9, s[36:37]
    global_load_short_d16_hi v173, v9, s[38:39]
    global_load_short_d16_hi v174, v9, s[48:49]
    s_barrier
    s_add_u32 s7, s3, s6
    s_and_b32 s100, s7, 3
    s_lshr_b32 s101, s7, 2
    s_and_b32 s101, s101, 1
    s_lshl_b32 s7, s100, 4
    s_lshl_b32 s8, s5, 6
    s_add_u32 s34, s7, s8
    s_lshl_b32 s7, s101, 5
    s_lshl_b32 s8, s6, 6
    s_add_u32 s35, s7, s8
    s_mul_i32 s13, s3, 4864
    s_mul_i32 s14, s3, 7168
    s_lshl_b32 s15, s3, 13
    s_add_u32 s15, s15, 96256
    s_and_b32 s60, s5, 3
    s_lshl_b32 s60, s60, 1
    s_mov_b32 s12, s6
    s_cmp_ge_u32 s3, 4
    s_cbranch_scc1 LI0
    s_lshl_b32 s7, s12, 7
    v_add_u32 v150, s7, v148
    s_lshl_b32 s7, s12, 10
    s_add_u32 m0, s7, s14
    s_add_u32 s12, s12, 1
    global_load_lds_dwordx4 v150, s[16:17]
    s_add_u32 m0, m0, 28672
    v_add_u32 v150, 7168, v150
    global_load_lds_dwordx4 v150, s[16:17]
    s_mov_b32 m0, s13
    s_cmp_eq_u32 s12, 7
    s_cselect_b32 s12, 0, s12
LI0:
    s_lshl_b32 s7, s60, 7
    v_add_u32 v150, s7, v149
    s_add_u32 m0, s15, 0
    s_add_u32 s60, s60, 1
    global_load_lds_dwordx4 v150, s[40:41]
    s_add_u32 m0, m0, 1024
    s_cmp_eq_u32 s60, 7
    global_load_lds_dwordx4 v150, s[42:43]
    s_cselect_b32 s60, 0, s60
    s_mov_b32 m0, s13
    s_lshl_b32 s7, s60, 7
    v_add_u32 v150, s7, v149
    s_add_u32 m0, s15, 2048
    s_add_u32 s60, s60, 1
    global_load_lds_dwordx4 v150, s[40:41]
    s_add_u32 m0, m0, 1024
    s_cmp_eq_u32 s60, 7
    global_load_lds_dwordx4 v150, s[42:43]
    s_cselect_b32 s60, 0, s60
    s_mov_b32 m0, s13
    s_lshl_b32 s7, s4, 14
    s_lshl_b32 s8, s3, 11
    s_add_u32 s7, s7, s8
    s_add_u32 s7, s7, 8388608
    v_lshl_add_u32 v151, v1, 4, s7
    v_and_b32 v108, 7, v2
    v_xor_b32 v109, v108, v3
    v_lshlrev_b32 v109, 4, v109
    v_lshl_add_u32 v109, v108, 7, v109
    v_lshrrev_b32 v108, 3, v2
    v_lshl_add_u32 v110, v108, 10, v109
    v_add_u32 v132, s15, v110
    v_xor_b32 v133, 64, v132
    v_add_u32 v134, s13, v110
    v_xor_b32 v135, 64, v134
    s_movk_i32 s7, 7168
    v_mad_u32_u24 v152, v108, s7, v109
    v_xor_b32 v153, 64, v152
    s_mul_i32 s7, s3, 2304
    s_add_u32 s22, s7, 141184
    v_and_b32 v92, 7, v1
    v_mul_u32_u24 v93, 80, v92
    v_add_u32 v93, s15, v93
    v_lshrrev_b32 v94, 3, v1
    v_lshl_add_u32 v95, v94, 3, v93
    v_mov_b32 v154, 0
    v_mov_b32 v155, 0
    s_lshl_b32 s7, s6, 15
    s_add_u32 s96, s58, s7
    s_addc_u32 s97, s59, 0
    s_mov_b32 s98, 32768
    s_mov_b32 s99, 0x20000
    s_lshl_b32 s7, s5, 10
    s_lshl_b32 s61, s3, 7
    s_add_u32 s7, s7, s61
    v_lshl_add_u32 v96, v92, 4, s7
    s_lshr_b32 s7, s3, 2
    s_lshl_b32 s7, s7, 5
    s_and_b32 s8, s3, 2
    s_lshl_b32 s8, s8, 1
    s_add_u32 s7, s7, s8
    s_and_b32 s8, s3, 1
    s_lshl_b32 s8, s8, 4
    s_add_u32 s7, s7, s8
    s_lshl_b32 s8, s6, 6
    s_add_u32 s7, s7, s8
    v_lshrrev_b32 v99, 2, v94
    v_and_b32 v100, 3, v94
    v_lshl_add_u32 v99, v99, 3, v100
    v_add_u32 v99, s7, v99
    v_mul_u32_u24 v99, 896, v99
    v_xor_b32 v100, v92, v94
    v_lshl_add_u32 v101, v100, 4, v99
    s_mov_b32 s20, 0x01000504
    s_mov_b32 s21, 0x03020706
    s_lshl_b32 s9, s3, 9
    s_sub_u32 s9, 118524, s9
    v_and_b32 v102, 33, v1
    v_lshlrev_b32 v102, 2, v102
    v_and_b32 v103, 14, v1
    v_lshl_add_u32 v102, v103, 3, v102
    v_bfe_u32 v103, v1, 4, 1
    v_lshl_add_u32 v102, v103, 3, v102
    v_sub_u32 v102, s9, v102
    v_lshlrev_b32 v99, 12, v94
    v_sub_u32 v99, v96, v99
    v_mov_b32 v100, -1
    v_subrev_u32 v184, 1024, v99
    v_cmp_le_i32 vcc, 0, v184
    s_nop 1
    v_cndmask_b32 v188, 0, v100, vcc
    v_subrev_u32 v185, 2048, v99
    v_cmp_le_i32 vcc, 0, v185
    s_nop 1
    v_cndmask_b32 v189, 0, v100, vcc
    v_subrev_u32 v186, 3072, v99
    v_cmp_le_i32 vcc, 0, v186
    s_nop 1
    v_cndmask_b32 v190, 0, v100, vcc
    v_subrev_u32 v187, 4096, v99
    v_cmp_le_i32 vcc, 0, v187
    s_nop 1
    v_cndmask_b32 v191, 0, v100, vcc
    s_and_b32 s18, s3, 3
    s_and_b32 s7, s3, 4
    s_mul_i32 s7, s7, 4864
    s_lshl_b32 s8, s18, 9
    s_add_u32 s8, s8, 512
    s_cmp_eq_u32 s18, 0
    s_cselect_b32 s8, 0, s8
    s_cselect_b32 s9, 4, 3
    s_add_u32 s7, s7, s8
    s_add_u32 s7, s7, 57344
    v_lshlrev_b32 v112, s9, v1
    v_add_u32 v112, s7, v112
    v_add_u32 v113, 4864, v112
    v_add_u32 v114, 9728, v112
    v_add_u32 v115, 14592, v112
    s_lshr_b32 s19, s3, 2
    s_mul_i32 s7, s19, 4672
    s_add_u32 s7, s7, 132320
    s_lshl_b32 s8, 256, s18
    s_cmp_eq_u32 s18, 0
    s_cselect_b32 s8, 0, s8
    s_add_u32 s7, s7, s8
    s_max_u32 s9, s18, 1
    s_add_u32 s9, s9, 2
    v_lshlrev_b32 v116, s9, v1
    v_add_u32 v116, s7, v116
    s_lshr_b32 s61, s3, 1
    s_and_b32 s61, s61, 1
    v_lshlrev_b32 v104, 3, v3
    v_sub_u32 v104, v104, v2
    v_add_u32 v104, 2031, v104
    v_and_b32 v105, 1, v104
    v_and_b32 v104, 0xfffe, v104
    v_lshlrev_b32 v104, 1, v104
    v_mul_u32_u24 v105, 4288, v105
    s_mul_i32 s7, s19, 8576
    s_add_u32 s7, s7, 113984
    s_lshl_b32 s61, s61, 8
    s_sub_u32 s7, s7, s61
    v_add3_u32 v104, v104, v105, s7
    v_subrev_u32 v105, 1024, v104
    v_subrev_u32 v106, 2048, v104
    v_subrev_u32 v107, 3072, v104
    s_mul_i32 s7, s19, 4672
    s_add_u32 s7, s7, 132096
    s_sub_u32 s7, s7, s61
    v_lshlrev_b32 v123, 5, v2
    v_lshl_add_u32 v123, v3, 4, v123
    v_add_u32 v123, s7, v123
    v_mul_u32_u24 v192, 80, v92
    v_add_u32 v192, s22, v192
    v_lshl_add_u32 v193, v94, 3, v192
    v_mul_u32_u24 v194, 144, v92
    v_lshl_add_u32 v194, v94, 4, v194
    v_add_u32 v194, s22, v194
    v_lshrrev_b32 v195, 2, v2
    v_mul_u32_u24 v195, 144, v195
    v_lshl_add_u32 v195, v3, 5, v195
    v_and_b32 v196, 3, v1
    v_lshl_add_u32 v195, v196, 3, v195
    v_add_u32 v195, s22, v195
    s_lshl_b32 s7, s6, 3
    s_add_u32 s7, s7, s3
    s_lshl_b32 s7, s7, 8
    s_mul_i32 s61, s5, 114688
    s_add_u32 s7, s7, s61
    s_add_u32 s7, s7, 262144
    v_mul_u32_u24 v196, 28672, v3
    v_lshl_add_u32 v196, v2, 4, v196
    v_add_u32 v196, s7, v196
    v_add_u32 v197, 14336, v196
    s_waitcnt lgkmcnt(0)
    s_add_u32 s31, s11, 0x9E3779B9
    s_lshl_b32 s7, s10, 16
    s_and_b32 s8, s10, 0xffff0000
    s_cmp_lt_u32 s3, 4
    s_cselect_b32 s7, s7, s8
    v_mov_b32 v4, s7
    v_mul_f32 v4, 0x3fb8aa3b, v4
    v_exp_f32 v4, v4
    s_nop 0
    v_cvt_pk_bf16_f32 v4, v4, v4
    v_lshlrev_b32 v4, 16, v4
    v_and_b32 v188, s31, v188
    v_and_b32 v189, s31, v189
    v_and_b32 v190, s31, v190
    v_and_b32 v191, s31, v191
    v_lshlrev_b32 v7, 4, v3
    v_add_u32 v7, s13, v7
    v_add_u32 v7, 57344, v7
    s_movk_i32 s7, 288
    v_mad_u32_u24 v5, v2, s7, v7
    v_min_u32 v6, 4, v2
    v_mad_u32_u24 v6, v6, s7, v7
    s_setprio 2
    s_waitcnt vmcnt(6)
    s_cmp_lt_u32 s3, 4
    s_cbranch_scc1 LI3
    s_waitcnt vmcnt(4)
LI3:
    v_mul_f32 v10, v4, v10
    v_mul_f32 v11, v4, v11
    v_mul_f32 v10, 0x3fb8aa3b, v10
    v_mul_f32 v11, 0x3e22f983, v11
    v_pk_mul_f32 v[12:13], v[12:13], v[4:5] op_sel:[0,0] op_sel_hi:[1,0]
    v_mul_f32 v16, 1.0, v10
    v_mul_f32 v17, 1.0, v11
    v_exp_f32 v16, v16
    v_rndne_f32 v18, v17
    v_sub_f32 v17, v17, v18
    v_cos_f32 v20, v17
    v_sin_f32 v21, v17
    s_nop 0
    v_pk_mul_f32 v[20:21], v[20:21], v[16:17] op_sel:[0,0] op_sel_hi:[1,0]
    v_mul_f32 v16, 0x43800000, v10
    v_mul_f32 v17, 0x43800000, v11
    v_exp_f32 v16, v16
    v_rndne_f32 v18, v17
    v_sub_f32 v17, v17, v18
    v_cos_f32 v32, v17
    v_sin_f32 v33, v17
    s_nop 0
    v_pk_mul_f32 v[32:33], v[32:33], v[16:17] op_sel:[0,0] op_sel_hi:[1,0]
    v_mul_f32 v16, 0x41000000, v10
    v_mul_f32 v17, 0x41000000, v11
    v_exp_f32 v16, v16
    v_rndne_f32 v18, v17
    v_sub_f32 v17, v17, v18
    v_cos_f32 v30, v17
    v_sin_f32 v31, v17
    s_nop 0
    v_pk_mul_f32 v[30:31], v[30:31], v[16:17] op_sel:[0,0] op_sel_hi:[1,0]
    v_pk_mul_f32 v[44:45], v[12:13], v[14:15] op_sel:[0,0] op_sel_hi:[0,1]
    v_pk_fma_f32 v[44:45], v[12:13], v[14:15], v[44:45] op_sel:[1,1,0] op_sel_hi:[1,0,1] neg_lo:[1,0,0]
    v_mov_b32 v8, 0x3f80
    ds_write_addtid_b32 v8 offset:57344
    v_cvt_pk_bf16_f32 v48, v20, -v21
    ds_write_addtid_b32 v48 offset:57632
    v_cvt_pk_bf16_f32 v49, v32, -v33
    ds_write_addtid_b32 v49 offset:59648
    v_pk_mul_f32 v[22:23], v[20:21], v[20:21] op_sel:[0,0] op_sel_hi:[0,1]
    v_pk_fma_f32 v[22:23], v[20:21], v[20:21], v[22:23] op_sel:[1,1,0] op_sel_hi:[1,0,1] neg_lo:[1,0,0]
    v_pk_mul_f32 v[34:35], v[32:33], v[32:33] op_sel:[0,0] op_sel_hi:[0,1]
    v_pk_fma_f32 v[34:35], v[32:33], v[32:33], v[34:35] op_sel:[1,1,0] op_sel_hi:[1,0,1] neg_lo:[1,0,0]
    v_cvt_pk_bf16_f32 v50, v22, -v23
    ds_write_addtid_b32 v50 offset:57920
    v_cvt_pk_bf16_f32 v51, v34, -v35
    ds_write_addtid_b32 v51 offset:60800
    v_pk_mul_f32 v[24:25], v[22:23], v[20:21] op_sel:[0,0] op_sel_hi:[0,1]
    v_pk_fma_f32 v[24:25], v[22:23], v[20:21], v[24:25] op_sel:[1,1,0] op_sel_hi:[1,0,1] neg_lo:[1,0,0]
    v_pk_mul_f32 v[26:27], v[22:23], v[22:23] op_sel:[0,0] op_sel_hi:[0,1]
    v_pk_fma_f32 v[26:27], v[22:23], v[22:23], v[26:27] op_sel:[1,1,0] op_sel_hi:[1,0,1] neg_lo:[1,0,0]
    v_cvt_pk_bf16_f32 v48, v24, -v25
    ds_write_addtid_b32 v48 offset:58208
    v_cvt_pk_bf16_f32 v49, v26, -v27
    ds_write_addtid_b32 v49 offset:58496
    v_pk_mul_f32 v[36:37], v[34:35], v[32:33] op_sel:[0,0] op_sel_hi:[0,1]
    v_pk_fma_f32 v[36:37], v[34:35], v[32:33], v[36:37] op_sel:[1,1,0] op_sel_hi:[1,0,1] neg_lo:[1,0,0]
    v_pk_mul_f32 v[28:29], v[26:27], v[22:23] op_sel:[0,0] op_sel_hi:[0,1]
    v_pk_fma_f32 v[28:29], v[26:27], v[22:23], v[28:29] op_sel:[1,1,0] op_sel_hi:[1,0,1] neg_lo:[1,0,0]
    v_cvt_pk_bf16_f32 v50, v36, -v37
    ds_write_addtid_b32 v50 offset:61376
    v_cvt_pk_bf16_f32 v51, v28, -v29
    ds_write_addtid_b32 v51 offset:59072
    v_pk_mul_f32 v[40:41], v[26:27], v[20:21] op_sel:[0,0] op_sel_hi:[0,1]
    v_pk_fma_f32 v[40:41], v[26:27], v[20:21], v[40:41] op_sel:[1,1,0] op_sel_hi:[1,0,1] neg_lo:[1,0,0]
    v_pk_mul_f32 v[42:43], v[26:27], v[24:25] op_sel:[0,0] op_sel_hi:[0,1]
    v_pk_fma_f32 v[42:43], v[26:27], v[24:25], v[42:43] op_sel:[1,1,0] op_sel_hi:[1,0,1] neg_lo:[1,0,0]
    v_cvt_pk_bf16_f32 v48, v40, -v41
    ds_write_addtid_b32 v48 offset:58784
    v_cvt_pk_bf16_f32 v49, v42, -v43
    ds_write_addtid_b32 v49 offset:59360
    v_pk_mul_f32 v[40:41], v[32:33], v[22:23] op_sel:[0,0] op_sel_hi:[0,1]
    v_pk_fma_f32 v[40:41], v[32:33], v[22:23], v[40:41] op_sel:[1,1,0] op_sel_hi:[1,0,1] neg_lo:[1,0,0]
    v_pk_mul_f32 v[42:43], v[32:33], v[26:27] op_sel:[0,0] op_sel_hi:[0,1]
    v_pk_fma_f32 v[42:43], v[32:33], v[26:27], v[42:43] op_sel:[1,1,0] op_sel_hi:[1,0,1] neg_lo:[1,0,0]
    v_cvt_pk_bf16_f32 v50, v40, -v41
    ds_write_addtid_b32 v50 offset:59936
    v_cvt_pk_bf16_f32 v51, v42, -v43
    ds_write_addtid_b32 v51 offset:60224
    v_pk_mul_f32 v[40:41], v[32:33], v[28:29] op_sel:[0,0] op_sel_hi:[0,1]
    v_pk_fma_f32 v[40:41], v[32:33], v[28:29], v[40:41] op_sel:[1,1,0] op_sel_hi:[1,0,1] neg_lo:[1,0,0]
    v_pk_mul_f32 v[42:43], v[34:35], v[26:27] op_sel:[0,0] op_sel_hi:[0,1]
    v_pk_fma_f32 v[42:43], v[34:35], v[26:27], v[42:43] op_sel:[1,1,0] op_sel_hi:[1,0,1] neg_lo:[1,0,0]
    v_cvt_pk_bf16_f32 v48, v40, -v41
    ds_write_addtid_b32 v48 offset:60512
    v_cvt_pk_bf16_f32 v49, v42, -v43
    ds_write_addtid_b32 v49 offset:61088
    v_pk_mul_f32 v[40:41], v[36:37], v[26:27] op_sel:[0,0] op_sel_hi:[0,1]
    v_pk_fma_f32 v[40:41], v[36:37], v[26:27], v[40:41] op_sel:[1,1,0] op_sel_hi:[1,0,1] neg_lo:[1,0,0]
    v_pk_mul_f32 v[38:39], v[34:35], v[34:35] op_sel:[0,0] op_sel_hi:[0,1]
    v_pk_fma_f32 v[38:39], v[34:35], v[34:35], v[38:39] op_sel:[1,1,0] op_sel_hi:[1,0,1] neg_lo:[1,0,0]
    v_cvt_pk_bf16_f32 v50, v40, -v41
    ds_write_addtid_b32 v50 offset:61664
    ds_read_b128 v[52:55], v5 offset:0
    ds_read_b128 v[56:59], v5 offset:64
    ds_read_b128 v[60:63], v5 offset:128
    ds_read_b128 v[64:67], v5 offset:192
    v_cvt_pk_bf16_f32 v51, v38, -v39
    ds_write_addtid_b32 v51 offset:57344
    v_pk_mul_f32 v[40:41], v[38:39], v[32:33] op_sel:[0,0] op_sel_hi:[0,1]
    v_pk_fma_f32 v[40:41], v[38:39], v[32:33], v[40:41] op_sel:[1,1,0] op_sel_hi:[1,0,1] neg_lo:[1,0,0]
    v_pk_mul_f32 v[42:43], v[38:39], v[34:35] op_sel:[0,0] op_sel_hi:[0,1]
    v_pk_fma_f32 v[42:43], v[38:39], v[34:35], v[42:43] op_sel:[1,1,0] op_sel_hi:[1,0,1] neg_lo:[1,0,0]
    v_cvt_pk_bf16_f32 v48, v40, -v41
    ds_write_addtid_b32 v48 offset:57632
    v_cvt_pk_bf16_f32 v49, v42, -v43
    ds_write_addtid_b32 v49 offset:57920
    v_pk_mul_f32 v[40:41], v[38:39], v[36:37] op_sel:[0,0] op_sel_hi:[0,1]
    v_pk_fma_f32 v[40:41], v[38:39], v[36:37], v[40:41] op_sel:[1,1,0] op_sel_hi:[1,0,1] neg_lo:[1,0,0]
    v_pk_mul_f32 v[42:43], v[38:39], v[38:39] op_sel:[0,0] op_sel_hi:[0,1]
    v_pk_fma_f32 v[42:43], v[38:39], v[38:39], v[42:43] op_sel:[1,1,0] op_sel_hi:[1,0,1] neg_lo:[1,0,0]
    v_cvt_pk_bf16_f32 v50, v40, -v41
    ds_write_addtid_b32 v50 offset:58208
    v_cvt_pk_bf16_f32 v51, v42, -v43
    ds_write_addtid_b32 v51 offset:58496
    ds_read_b128 v[68:71], v6 offset:0
    ds_read_b128 v[72:75], v6 offset:64
    ds_read_b128 v[76:79], v6 offset:128
    ds_read_b128 v[80:83], v6 offset:192
    v_pk_mul_f32 v[46:47], v[44:45], v[30:31] op_sel:[0,0] op_sel_hi:[0,1]
    v_pk_fma_f32 v[46:47], v[44:45], v[30:31], v[46:47] op_sel:[1,1,0] op_sel_hi:[1,0,1] neg_lo:[1,0,0]
    v_pk_mul_f32 v[22:23], v[30:31], v[30:31] op_sel:[0,0] op_sel_hi:[0,1]
    v_pk_fma_f32 v[22:23], v[30:31], v[30:31], v[22:23] op_sel:[1,1,0] op_sel_hi:[1,0,1] neg_lo:[1,0,0]
    v_cvt_pk_bf16_f32 v48, v44, v45
    ds_write_addtid_b32 v48 offset:57344
    v_cvt_pk_bf16_f32 v49, v46, v47
    ds_write_addtid_b32 v49 offset:57632
    v_pk_mul_f32 v[40:41], v[44:45], v[22:23] op_sel:[0,0] op_sel_hi:[0,1]
    v_pk_fma_f32 v[40:41], v[44:45], v[22:23], v[40:41] op_sel:[1,1,0] op_sel_hi:[1,0,1] neg_lo:[1,0,0]
    v_pk_mul_f32 v[42:43], v[46:47], v[22:23] op_sel:[0,0] op_sel_hi:[0,1]
    v_pk_fma_f32 v[42:43], v[46:47], v[22:23], v[42:43] op_sel:[1,1,0] op_sel_hi:[1,0,1] neg_lo:[1,0,0]
    v_cvt_pk_bf16_f32 v50, v40, v41
    ds_write_addtid_b32 v50 offset:57920
    v_cvt_pk_bf16_f32 v51, v42, v43
    ds_write_addtid_b32 v51 offset:58208
    v_pk_mul_f32 v[44:45], v[40:41], v[22:23] op_sel:[0,0] op_sel_hi:[0,1]
    v_pk_fma_f32 v[44:45], v[40:41], v[22:23], v[44:45] op_sel:[1,1,0] op_sel_hi:[1,0,1] neg_lo:[1,0,0]
    v_pk_mul_f32 v[46:47], v[42:43], v[22:23] op_sel:[0,0] op_sel_hi:[0,1]
    v_pk_fma_f32 v[46:47], v[42:43], v[22:23], v[46:47] op_sel:[1,1,0] op_sel_hi:[1,0,1] neg_lo:[1,0,0]
    v_cvt_pk_bf16_f32 v48, v44, v45
    ds_write_addtid_b32 v48 offset:58496
    v_cvt_pk_bf16_f32 v49, v46, v47
    ds_write_addtid_b32 v49 offset:58784
    v_pk_mul_f32 v[40:41], v[44:45], v[22:23] op_sel:[0,0] op_sel_hi:[0,1]
    v_pk_fma_f32 v[40:41], v[44:45], v[22:23], v[40:41] op_sel:[1,1,0] op_sel_hi:[1,0,1] neg_lo:[1,0,0]
    v_pk_mul_f32 v[42:43], v[46:47], v[22:23] op_sel:[0,0] op_sel_hi:[0,1]
    v_pk_fma_f32 v[42:43], v[46:47], v[22:23], v[42:43] op_sel:[1,1,0] op_sel_hi:[1,0,1] neg_lo:[1,0,0]
    v_cvt_pk_bf16_f32 v50, v40, v41
    ds_write_addtid_b32 v50 offset:59072
    v_cvt_pk_bf16_f32 v51, v42, v43
    ds_write_addtid_b32 v51 offset:59360
    v_pk_mul_f32 v[44:45], v[40:41], v[22:23] op_sel:[0,0] op_sel_hi:[0,1]
    v_pk_fma_f32 v[44:45], v[40:41], v[22:23], v[44:45] op_sel:[1,1,0] op_sel_hi:[1,0,1] neg_lo:[1,0,0]
    v_pk_mul_f32 v[46:47], v[42:43], v[22:23] op_sel:[0,0] op_sel_hi:[0,1]
    v_pk_fma_f32 v[46:47], v[42:43], v[22:23], v[46:47] op_sel:[1,1,0] op_sel_hi:[1,0,1] neg_lo:[1,0,0]
    v_cvt_pk_bf16_f32 v48, v44, v45
    ds_write_addtid_b32 v48 offset:59648
    v_cvt_pk_bf16_f32 v49, v46, v47
    ds_write_addtid_b32 v49 offset:59936
    v_pk_mul_f32 v[40:41], v[44:45], v[22:23] op_sel:[0,0] op_sel_hi:[0,1]
    v_pk_fma_f32 v[40:41], v[44:45], v[22:23], v[40:41] op_sel:[1,1,0] op_sel_hi:[1,0,1] neg_lo:[1,0,0]
    v_pk_mul_f32 v[42:43], v[46:47], v[22:23] op_sel:[0,0] op_sel_hi:[0,1]
    v_pk_fma_f32 v[42:43], v[46:47], v[22:23], v[42:43] op_sel:[1,1,0] op_sel_hi:[1,0,1] neg_lo:[1,0,0]
    v_cvt_pk_bf16_f32 v50, v40, v41
    ds_write_addtid_b32 v50 offset:60224
    v_cvt_pk_bf16_f32 v51, v42, v43
    ds_write_addtid_b32 v51 offset:60512
    v_pk_mul_f32 v[44:45], v[40:41], v[22:23] op_sel:[0,0] op_sel_hi:[0,1]
    v_pk_fma_f32 v[44:45], v[40:41], v[22:23], v[44:45] op_sel:[1,1,0] op_sel_hi:[1,0,1] neg_lo:[1,0,0]
    v_pk_mul_f32 v[46:47], v[42:43], v[22:23] op_sel:[0,0] op_sel_hi:[0,1]
    v_pk_fma_f32 v[46:47], v[42:43], v[22:23], v[46:47] op_sel:[1,1,0] op_sel_hi:[1,0,1] neg_lo:[1,0,0]
    v_cvt_pk_bf16_f32 v48, v44, v45
    ds_write_addtid_b32 v48 offset:60800
    v_cvt_pk_bf16_f32 v49, v46, v47
    ds_write_addtid_b32 v49 offset:61088
    v_pk_mul_f32 v[40:41], v[44:45], v[22:23] op_sel:[0,0] op_sel_hi:[0,1]
    v_pk_fma_f32 v[40:41], v[44:45], v[22:23], v[40:41] op_sel:[1,1,0] op_sel_hi:[1,0,1] neg_lo:[1,0,0]
    v_pk_mul_f32 v[42:43], v[46:47], v[22:23] op_sel:[0,0] op_sel_hi:[0,1]
    v_pk_fma_f32 v[42:43], v[46:47], v[22:23], v[42:43] op_sel:[1,1,0] op_sel_hi:[1,0,1] neg_lo:[1,0,0]
    v_cvt_pk_bf16_f32 v50, v40, v41
    ds_write_addtid_b32 v50 offset:61376
    v_cvt_pk_bf16_f32 v51, v42, v43
    ds_write_addtid_b32 v51 offset:61664
    v_pk_mul_f32 v[44:45], v[40:41], v[22:23] op_sel:[0,0] op_sel_hi:[0,1]
    v_pk_fma_f32 v[44:45], v[40:41], v[22:23], v[44:45] op_sel:[1,1,0] op_sel_hi:[1,0,1] neg_lo:[1,0,0]
    v_pk_mul_f32 v[46:47], v[42:43], v[22:23] op_sel:[0,0] op_sel_hi:[0,1]
    v_pk_fma_f32 v[46:47], v[42:43], v[22:23], v[46:47] op_sel:[1,1,0] op_sel_hi:[1,0,1] neg_lo:[1,0,0]
    ds_read_b128 v[200:203], v5 offset:0
    ds_read_b128 v[204:207], v5 offset:64
    ds_read_b128 v[208:211], v5 offset:128
    ds_read_b128 v[212:215], v5 offset:192
    v_cvt_pk_bf16_f32 v48, v44, v45
    ds_write_addtid_b32 v48 offset:57344
    v_cvt_pk_bf16_f32 v49, v46, v47
    ds_write_addtid_b32 v49 offset:57632
    v_pk_mul_f32 v[40:41], v[44:45], v[22:23] op_sel:[0,0] op_sel_hi:[0,1]
    v_pk_fma_f32 v[40:41], v[44:45], v[22:23], v[40:41] op_sel:[1,1,0] op_sel_hi:[1,0,1] neg_lo:[1,0,0]
    v_pk_mul_f32 v[42:43], v[46:47], v[22:23] op_sel:[0,0] op_sel_hi:[0,1]
    v_pk_fma_f32 v[42:43], v[46:47], v[22:23], v[42:43] op_sel:[1,1,0] op_sel_hi:[1,0,1] neg_lo:[1,0,0]
    v_cvt_pk_bf16_f32 v50, v40, v41
    ds_write_addtid_b32 v50 offset:57920
    v_cvt_pk_bf16_f32 v51, v42, v43
    ds_write_addtid_b32 v51 offset:58208
    v_pk_mul_f32 v[44:45], v[40:41], v[22:23] op_sel:[0,0] op_sel_hi:[0,1]
    v_pk_fma_f32 v[44:45], v[40:41], v[22:23], v[44:45] op_sel:[1,1,0] op_sel_hi:[1,0,1] neg_lo:[1,0,0]
    v_pk_mul_f32 v[46:47], v[42:43], v[22:23] op_sel:[0,0] op_sel_hi:[0,1]
    v_pk_fma_f32 v[46:47], v[42:43], v[22:23], v[46:47] op_sel:[1,1,0] op_sel_hi:[1,0,1] neg_lo:[1,0,0]
    v_cvt_pk_bf16_f32 v48, v44, v45
    ds_write_addtid_b32 v48 offset:58496
    v_cvt_pk_bf16_f32 v49, v46, v47
    ds_write_addtid_b32 v49 offset:58784
    v_pk_mul_f32 v[40:41], v[44:45], v[22:23] op_sel:[0,0] op_sel_hi:[0,1]
    v_pk_fma_f32 v[40:41], v[44:45], v[22:23], v[40:41] op_sel:[1,1,0] op_sel_hi:[1,0,1] neg_lo:[1,0,0]
    v_pk_mul_f32 v[42:43], v[46:47], v[22:23] op_sel:[0,0] op_sel_hi:[0,1]
    v_pk_fma_f32 v[42:43], v[46:47], v[22:23], v[42:43] op_sel:[1,1,0] op_sel_hi:[1,0,1] neg_lo:[1,0,0]
    s_waitcnt lgkmcnt(6)
    v_mfma_f32_16x16x32_bf16 v[232:235], v[52:55], v[200:203], 0
    v_mfma_f32_16x16x32_bf16 v[232:235], v[56:59], v[204:207], v[232:235]
    v_mfma_f32_16x16x32_bf16 v[232:235], v[60:63], v[208:211], v[232:235]
    v_mfma_f32_16x16x32_bf16 v[232:235], v[64:67], v[212:215], v[232:235]
    v_mfma_f32_16x16x32_bf16 v[240:243], v[68:71], v[200:203], 0
    v_mfma_f32_16x16x32_bf16 v[240:243], v[72:75], v[204:207], v[240:243]
    v_mfma_f32_16x16x32_bf16 v[240:243], v[76:79], v[208:211], v[240:243]
    v_mfma_f32_16x16x32_bf16 v[240:243], v[80:83], v[212:215], v[240:243]
    v_cvt_pk_bf16_f32 v50, v40, v41
    ds_write_addtid_b32 v50 offset:59072
    v_cvt_pk_bf16_f32 v51, v42, v43
    ds_write_addtid_b32 v51 offset:59360
    v_pk_mul_f32 v[44:45], v[40:41], v[22:23] op_sel:[0,0] op_sel_hi:[0,1]
    v_pk_fma_f32 v[44:45], v[40:41], v[22:23], v[44:45] op_sel:[1,1,0] op_sel_hi:[1,0,1] neg_lo:[1,0,0]
    v_pk_mul_f32 v[46:47], v[42:43], v[22:23] op_sel:[0,0] op_sel_hi:[0,1]
    v_pk_fma_f32 v[46:47], v[42:43], v[22:23], v[46:47] op_sel:[1,1,0] op_sel_hi:[1,0,1] neg_lo:[1,0,0]
    v_cvt_pk_bf16_f32 v48, v44, v45
    ds_write_addtid_b32 v48 offset:59648
    v_cvt_pk_bf16_f32 v49, v46, v47
    ds_write_addtid_b32 v49 offset:59936
    v_pk_mul_f32 v[40:41], v[44:45], v[22:23] op_sel:[0,0] op_sel_hi:[0,1]
    v_pk_fma_f32 v[40:41], v[44:45], v[22:23], v[40:41] op_sel:[1,1,0] op_sel_hi:[1,0,1] neg_lo:[1,0,0]
    v_pk_mul_f32 v[42:43], v[46:47], v[22:23] op_sel:[0,0] op_sel_hi:[0,1]
    v_pk_fma_f32 v[42:43], v[46:47], v[22:23], v[42:43] op_sel:[1,1,0] op_sel_hi:[1,0,1] neg_lo:[1,0,0]
    v_cvt_pk_bf16_f32 v50, v40, v41
    ds_write_addtid_b32 v50 offset:60224
    v_cvt_pk_bf16_f32 v51, v42, v43
    ds_write_addtid_b32 v51 offset:60512
    v_pk_mul_f32 v[44:45], v[40:41], v[22:23] op_sel:[0,0] op_sel_hi:[0,1]
    v_pk_fma_f32 v[44:45], v[40:41], v[22:23], v[44:45] op_sel:[1,1,0] op_sel_hi:[1,0,1] neg_lo:[1,0,0]
    v_pk_mul_f32 v[46:47], v[42:43], v[22:23] op_sel:[0,0] op_sel_hi:[0,1]
    v_pk_fma_f32 v[46:47], v[42:43], v[22:23], v[46:47] op_sel:[1,1,0] op_sel_hi:[1,0,1] neg_lo:[1,0,0]
    v_cvt_pk_bf16_f32 v48, v44, v45
    ds_write_addtid_b32 v48 offset:60800
    v_cvt_pk_bf16_f32 v49, v46, v47
    ds_write_addtid_b32 v49 offset:61088
    v_pk_mul_f32 v[40:41], v[44:45], v[22:23] op_sel:[0,0] op_sel_hi:[0,1]
    v_pk_fma_f32 v[40:41], v[44:45], v[22:23], v[40:41] op_sel:[1,1,0] op_sel_hi:[1,0,1] neg_lo:[1,0,0]
    v_pk_mul_f32 v[42:43], v[46:47], v[22:23] op_sel:[0,0] op_sel_hi:[0,1]
    v_pk_fma_f32 v[42:43], v[46:47], v[22:23], v[42:43] op_sel:[1,1,0] op_sel_hi:[1,0,1] neg_lo:[1,0,0]
    v_cvt_pk_bf16_f32 v50, v40, v41
    ds_write_addtid_b32 v50 offset:61376
    v_cvt_pk_bf16_f32 v51, v42, v43
    ds_write_addtid_b32 v51 offset:61664
    ds_read_b128 v[216:219], v5 offset:0
    ds_read_b128 v[220:223], v5 offset:64
    ds_read_b128 v[224:227], v5 offset:128
    ds_read_b128 v[228:231], v5 offset:192
    v_max_u32 v8, 1, v3
    v_lshrrev_b32 v8, v8, 64
    v_mul_u32_u24 v9, v8, v2
    v_lshlrev_b32 v10, 4, v3
    v_lshlrev_b32 v11, 9, v3
    v_cmp_gt_u32 vcc, 2, v3
    s_nop 1
    v_cndmask_b32 v10, v11, v10, vcc
    v_add3_u32 v9, v9, v10, s13
    v_cmp_eq_u32 vcc, 3, v3
    v_mov_b32 v11, 256
    s_nop 0
    v_cndmask_b32 v11, 8, v11, vcc
    v_add_u32 v10, v9, v11
    v_lshl_add_u32 v11, v8, 4, v9
    v_lshl_add_u32 v12, v8, 4, v10
    v_lshlrev_b32 v13, 9, v3
    v_lshl_add_u32 v13, v2, 2, v13
    v_add_u32 v13, s13, v13
    v_add_u32 v13, 59392, v13
    s_waitcnt lgkmcnt(0)
    v_mfma_f32_16x16x32_bf16 v[236:239], v[52:55], v[216:219], 0
    v_mfma_f32_16x16x32_bf16 v[236:239], v[56:59], v[220:223], v[236:239]
    v_mfma_f32_16x16x32_bf16 v[236:239], v[60:63], v[224:227], v[236:239]
    v_mfma_f32_16x16x32_bf16 v[236:239], v[64:67], v[228:231], v[236:239]
    v_mfma_f32_16x16x32_bf16 v[244:247], v[68:71], v[216:219], 0
    v_mfma_f32_16x16x32_bf16 v[244:247], v[72:75], v[220:223], v[244:247]
    v_mfma_f32_16x16x32_bf16 v[244:247], v[76:79], v[224:227], v[244:247]
    v_mfma_f32_16x16x32_bf16 v[244:247], v[80:83], v[228:231], v[244:247]
    ds_write_b64 v9, v[232:233] offset:57344
    ds_write_b64 v10, v[234:235] offset:57344
    s_nop 1
    ds_write_b64 v11, v[236:237] offset:57344
    ds_write_b64 v12, v[238:239] offset:57344
    ds_write2_b32 v13, v240, v241 offset0:0 offset1:32
    ds_write2_b32 v13, v242, v243 offset0:64 offset1:96
    ds_write2_b32 v13, v244, v245 offset0:16 offset1:48
    ds_write2_b32 v13, v246, v247 offset0:80 offset1:112
    s_waitcnt vmcnt(0)
    ds_read_b128 v[200:203], v132 offset:0
    ds_read_b128 v[204:207], v133 offset:0
    ds_read_b128 v[208:211], v132 offset:2048
    ds_read_b128 v[212:215], v133 offset:2048
    s_cmp_ge_u32 s3, 4
    s_cbranch_scc1 LI2
    s_setprio 0
    s_waitcnt vmcnt(16)
    s_lshl_b32 s7, s12, 7
    v_add_u32 v150, s7, v148
    s_lshl_b32 s7, s12, 10
    s_add_u32 m0, s7, s14
    s_add_u32 s12, s12, 1
    global_load_lds_dwordx4 v150, s[16:17]
    s_add_u32 m0, m0, 28672
    v_add_u32 v150, 7168, v150
    global_load_lds_dwordx4 v150, s[16:17]
    s_mov_b32 m0, s13
    s_cmp_eq_u32 s12, 7
    s_cselect_b32 s12, 0, s12
    s_waitcnt vmcnt(16)
    s_lshl_b32 s7, s12, 7
    v_add_u32 v150, s7, v148
    s_lshl_b32 s7, s12, 10
    s_add_u32 m0, s7, s14
    s_add_u32 s12, s12, 1
    global_load_lds_dwordx4 v150, s[16:17]
    s_add_u32 m0, m0, 28672
    v_add_u32 v150, 7168, v150
    global_load_lds_dwordx4 v150, s[16:17]
    s_mov_b32 m0, s13
    s_cmp_eq_u32 s12, 7
    s_cselect_b32 s12, 0, s12
    s_waitcnt vmcnt(16)
    s_lshl_b32 s7, s12, 7
    v_add_u32 v150, s7, v148
    s_lshl_b32 s7, s12, 10
    s_add_u32 m0, s7, s14
    s_add_u32 s12, s12, 1
    global_load_lds_dwordx4 v150, s[16:17]
    s_add_u32 m0, m0, 28672
    v_add_u32 v150, 7168, v150
    global_load_lds_dwordx4 v150, s[16:17]
    s_mov_b32 m0, s13
    s_cmp_eq_u32 s12, 7
    s_cselect_b32 s12, 0, s12
    s_waitcnt vmcnt(16)
    s_lshl_b32 s7, s12, 7
    v_add_u32 v150, s7, v148
    s_lshl_b32 s7, s12, 10
    s_add_u32 m0, s7, s14
    s_add_u32 s12, s12, 1
    global_load_lds_dwordx4 v150, s[16:17]
    s_add_u32 m0, m0, 28672
    v_add_u32 v150, 7168, v150
    global_load_lds_dwordx4 v150, s[16:17]
    s_mov_b32 m0, s13
    s_cmp_eq_u32 s12, 7
    s_cselect_b32 s12, 0, s12
    s_waitcnt vmcnt(16)
    s_lshl_b32 s7, s12, 7
    v_add_u32 v150, s7, v148
    s_lshl_b32 s7, s12, 10
    s_add_u32 m0, s7, s14
    s_add_u32 s12, s12, 1
    global_load_lds_dwordx4 v150, s[16:17]
    s_add_u32 m0, m0, 28672
    v_add_u32 v150, 7168, v150
    global_load_lds_dwordx4 v150, s[16:17]
    s_mov_b32 m0, s13
    s_cmp_eq_u32 s12, 7
    s_cselect_b32 s12, 0, s12
    s_waitcnt vmcnt(16)
    s_lshl_b32 s7, s12, 7
    v_add_u32 v150, s7, v148
    s_lshl_b32 s7, s12, 10
    s_add_u32 m0, s7, s14
    s_add_u32 s12, s12, 1
    global_load_lds_dwordx4 v150, s[16:17]
    s_add_u32 m0, m0, 28672
    v_add_u32 v150, 7168, v150
    global_load_lds_dwordx4 v150, s[16:17]
    s_mov_b32 m0, s13
    s_cmp_eq_u32 s12, 7
    s_cselect_b32 s12, 0, s12
    s_waitcnt vmcnt(16)
    s_lshl_b32 s7, s60, 7
    v_add_u32 v150, s7, v149
    s_add_u32 m0, s15, 4096
    s_add_u32 s60, s60, 1
    global_load_lds_dwordx4 v150, s[40:41]
    s_add_u32 m0, m0, 1024
    s_cmp_eq_u32 s60, 7
    global_load_lds_dwordx4 v150, s[42:43]
    s_cselect_b32 s60, 0, s60
    v_add_u32 v150, 28672, v150
    s_add_u32 m0, s15, 36864
    s_nop 0
    global_load_lds_dwordx4 v150, s[40:41]
    s_add_u32 m0, m0, 1024
    s_nop 0
    global_load_lds_dwordx4 v150, s[42:43]
    s_mov_b32 m0, s13
    s_waitcnt vmcnt(16)
    s_lshl_b32 s7, s60, 7
    v_add_u32 v150, s7, v149
    s_add_u32 m0, s15, 6144
    s_add_u32 s60, s60, 1
    global_load_lds_dwordx4 v150, s[40:41]
    s_add_u32 m0, m0, 1024
    s_cmp_eq_u32 s60, 7
    global_load_lds_dwordx4 v150, s[42:43]
    s_cselect_b32 s60, 0, s60
    v_add_u32 v150, 28672, v150
    s_add_u32 m0, s15, 38912
    s_nop 0
    global_load_lds_dwordx4 v150, s[40:41]
    s_add_u32 m0, m0, 1024
    s_nop 0
    global_load_lds_dwordx4 v150, s[42:43]
    s_mov_b32 m0, s13
    s_nop 0
    s_branch LI6
LI2:
    s_setprio 2
    s_add_u32 s60, s60, 2
    s_sub_u32 s7, s60, 7
    s_cselect_b32 s60, s60, s7
LI6:
    s_waitcnt lgkmcnt(0)
    s_waitcnt vmcnt(16)
    s_lshl_b32 s7, s60, 7
    v_add_u32 v150, s7, v149
    s_add_u32 m0, s13, 60160
    s_add_u32 s60, s60, 1
    global_load_lds_dwordx4 v150, s[40:41]
    s_add_u32 m0, m0, 1024
    s_cmp_eq_u32 s60, 7
    global_load_lds_dwordx4 v150, s[42:43]
    s_cselect_b32 s60, 0, s60
    s_mov_b32 m0, s13
    s_waitcnt vmcnt(16)
    s_lshl_b32 s7, s60, 7
    v_add_u32 v150, s7, v149
    s_add_u32 m0, s15, 0
    s_add_u32 s60, s60, 1
    global_load_lds_dwordx4 v150, s[40:41]
    s_add_u32 m0, m0, 1024
    s_cmp_eq_u32 s60, 7
    global_load_lds_dwordx4 v150, s[42:43]
    s_cselect_b32 s60, 0, s60
    s_mov_b32 m0, s13
    s_waitcnt vmcnt(16)
    s_lshl_b32 s7, s60, 7
    v_add_u32 v150, s7, v149
    s_add_u32 m0, s15, 2048
    s_add_u32 s60, s60, 1
    global_load_lds_dwordx4 v150, s[40:41]
    s_add_u32 m0, m0, 1024
    s_cmp_eq_u32 s60, 7
    global_load_lds_dwordx4 v150, s[42:43]
    s_cselect_b32 s60, 0, s60
    s_mov_b32 m0, s13
    s_cmp_ge_u32 s3, 4
    s_cbranch_scc1 LI5
    v_and_b32 v4, 4, v1
    v_and_b32 v5, 1, v1
    v_lshl_add_u32 v4, v5, 1, v4
    v_lshrrev_b32 v5, 3, v1
    v_xor_b32 v6, v5, v4
    v_lshlrev_b32 v6, 4, v6
    v_lshl_add_u32 v6, v4, 7, v6
    v_bfe_u32 v7, v1, 1, 1
    v_mul_u32_u24 v7, 28672, v7
    s_lshl_b32 s7, s6, 10
    s_add_u32 s7, s7, s14
    v_add3_u32 v6, v6, v7, s7
    v_xor_b32 v7, 16, v6
    ds_read_b128 v[20:23], v6
    ds_read_b128 v[24:27], v7 offset:128
    s_lshl_b32 s7, s6, 19
    s_lshl_b32 s8, s5, 2
    s_add_u32 s8, s8, s3
    s_lshl_b32 s8, s8, 7
    s_add_u32 s7, s7, s8
    s_add_u32 s7, s7, 8388608
    v_and_b32 v4, 7, v1
    v_lshl_add_u32 v4, v4, 4, s7
    v_lshl_add_u32 v4, v5, 16, v4
    v_mov_b32 v29, s31
    v_mov_b32 v31, s31
    v_add_u32 v8, 0, v4
    v_mov_b32 v33, s31
    v_mov_b32 v35, s31
    v_add_u32 v9, 16384, v4
    v_mov_b32 v37, s31
    v_mov_b32 v39, s31
    v_add_u32 v10, 32768, v4
    v_mov_b32 v41, s31
    v_mov_b32 v43, s31
    v_add_u32 v11, 49152, v4
    s_waitcnt lgkmcnt(0)
    v_mov_b32 v28, v20
    v_mov_b32 v30, v24
    global_store_dwordx4 v8, v[28:31], s[58:59] sc1
    v_mov_b32 v32, v21
    v_mov_b32 v34, v25
    global_store_dwordx4 v9, v[32:35], s[58:59] sc1
    v_mov_b32 v36, v22
    v_mov_b32 v38, v26
    global_store_dwordx4 v10, v[36:39], s[58:59] sc1
    v_mov_b32 v40, v23
    v_mov_b32 v42, v27
    global_store_dwordx4 v11, v[40:43], s[58:59] sc1
    s_nop 1
LI5:
    s_lshl_b32 s7, s60, 10
    v_add_u32 v148, s7, v152
    v_xor_b32 v149, 64, v148
    v_mov_b32 v10, 161792
    v_mov_b32 v11, 1
    s_waitcnt vmcnt(4)
    s_cmp_lt_u32 s3, 4
    s_cbranch_scc1 LA2
    s_waitcnt vmcnt(0)
    s_branch LA0
LA2:
    s_mov_b64 exec, 1
    ds_add_u32 v10, v11 offset:4
    s_mov_b64 exec, -1
LA0:
    ds_read_b128 v[232:235], v134 offset:60160
    ds_read_b128 v[236:239], v135 offset:60160
    ds_read_b128 v[240:243], v132 offset:0
    ds_read_b128 v[244:247], v133 offset:0
    ds_read_b128 v[248:251], v132 offset:2048
    ds_read_b128 v[252:255], v133 offset:2048
LA1:
    ds_read_b32 v11, v10 offset:4
    s_waitcnt lgkmcnt(0)
    v_readfirstlane_b32 s7, v11
    s_cmp_lt_u32 s7, 4
    s_nop 3
    s_cbranch_scc1 LA1
    ds_read_b128 v[216:219], v132 offset:4096
    ds_read_b128 v[220:223], v133 offset:4096
    ds_read_b128 v[224:227], v132 offset:6144
    ds_read_b128 v[228:231], v133 offset:6144
    s_mov_b32 s13, s60
    ds_read_b128 v[28:31], v148 offset:0
    ds_read_b128 v[32:35], v148 offset:14336
    ds_read_b128 v[36:39], v148 offset:28672
    ds_read_b128 v[40:43], v148 offset:43008
    ds_read_b128 v[44:47], v149 offset:0
    ds_read_b128 v[48:51], v149 offset:14336
    ds_read_b128 v[52:55], v149 offset:28672
    ds_read_b128 v[56:59], v149 offset:43008
    s_add_u32 s13, s13, 1
    s_cmp_eq_u32 s13, 7
    s_cselect_b32 s13, 0, s13
    v_lshl_add_u32 v148, s13, 10, v152
    v_xor_b32 v149, 64, v148
    ds_read_b128 v[60:63], v148 offset:0
    ds_read_b128 v[64:67], v148 offset:14336
    ds_read_b128 v[68:71], v148 offset:28672
    ds_read_b128 v[72:75], v148 offset:43008
    global_load_dwordx4 v[140:143], v151, s[58:59] sc1
    global_load_dwordx4 v[144:147], v151, s[58:59] offset:1024 sc1
    s_waitcnt lgkmcnt(8)
    v_mfma_f32_16x16x32_bf16 v[124:127], v[28:31], v[200:203], 0
    ds_read_b128 v[76:79], v149 offset:0
    v_mul_f32 v4, 0x3fb8aa3b, v174
    v_exp_f32 v4, v4
    v_mfma_f32_16x16x32_bf16 v[128:131], v[32:35], v[200:203], 0
    ds_read_b128 v[80:83], v149 offset:14336
    v_cvt_pk_bf16_f32 v4, v4, v4
    v_lshlrev_b32 v4, 16, v4
    v_mfma_f32_16x16x32_bf16 v[132:135], v[36:39], v[200:203], 0
    ds_read_b128 v[84:87], v149 offset:28672
    v_mov_b32 v6, v172
    v_mov_b32 v7, v173
    v_mfma_f32_16x16x32_bf16 v[136:139], v[40:43], v[200:203], 0
    ds_read_b128 v[88:91], v149 offset:43008
    s_add_u32 s13, s13, 1
    s_cmp_eq_u32 s13, 7
    s_cselect_b32 s13, 0, s13
    v_lshl_add_u32 v148, s13, 10, v152
    v_xor_b32 v149, 64, v148
    v_mul_f32 v10, v4, v172
    v_mul_f32 v11, v4, v173
    s_waitcnt lgkmcnt(8)
    v_mfma_f32_16x16x32_bf16 v[124:127], v[44:47], v[204:207], v[124:127]
    ds_read_b128 v[28:31], v148 offset:0
    v_mul_f32 v10, 0x3fb8aa3b, v10
    v_mul_f32 v11, 0x3e22f983, v11
    v_mfma_f32_16x16x32_bf16 v[128:131], v[48:51], v[204:207], v[128:131]
    ds_read_b128 v[32:35], v148 offset:14336
    v_lshrrev_b32 v8, 3, v1
    v_cvt_f32_u32 v8, v8
    v_mfma_f32_16x16x32_bf16 v[132:135], v[52:55], v[204:207], v[132:135]
    ds_read_b128 v[36:39], v148 offset:28672
    v_mul_f32 v9, 0x43800000, v8
    v_mul_f32 v8, 0x41000000, v8
    v_mfma_f32_16x16x32_bf16 v[136:139], v[56:59], v[204:207], v[136:139]
    ds_read_b128 v[40:43], v148 offset:43008
    v_mul_f32 v16, 1.0, v10
    v_mul_f32 v17, 1.0, v11
    s_waitcnt lgkmcnt(8)
    v_mfma_f32_16x16x32_bf16 v[124:127], v[60:63], v[208:211], v[124:127]
    ds_read_b128 v[44:47], v149 offset:0
    v_exp_f32 v16, v16
    v_rndne_f32 v18, v17
    v_mfma_f32_16x16x32_bf16 v[128:131], v[64:67], v[208:211], v[128:131]
    ds_read_b128 v[48:51], v149 offset:14336
    v_sub_f32 v17, v17, v18
    v_cos_f32 v172, v17
    v_mfma_f32_16x16x32_bf16 v[132:135], v[68:71], v[208:211], v[132:135]
    ds_read_b128 v[52:55], v149 offset:28672
    v_sin_f32 v173, v17
    s_nop 0
    v_pk_mul_f32 v[172:173], v[172:173], v[16:17] op_sel:[0,0] op_sel_hi:[1,0]
    v_mfma_f32_16x16x32_bf16 v[136:139], v[72:75], v[208:211], v[136:139]
    ds_read_b128 v[56:59], v149 offset:43008
    s_add_u32 s13, s13, 1
    s_cmp_eq_u32 s13, 7
    s_cselect_b32 s13, 0, s13
    v_lshl_add_u32 v148, s13, 10, v152
    v_xor_b32 v149, 64, v148
    v_mul_f32 v16, 0x41000000, v10
    v_mul_f32 v17, 0x41000000, v11
    s_waitcnt lgkmcnt(8)
    v_mfma_f32_16x16x32_bf16 v[124:127], v[76:79], v[212:215], v[124:127]
    ds_read_b128 v[60:63], v148 offset:0
    v_exp_f32 v16, v16
    v_rndne_f32 v18, v17
    v_mfma_f32_16x16x32_bf16 v[128:131], v[80:83], v[212:215], v[128:131]
    ds_read_b128 v[64:67], v148 offset:14336
    v_sub_f32 v17, v17, v18
    v_cos_f32 v174, v17
    v_mfma_f32_16x16x32_bf16 v[132:135], v[84:87], v[212:215], v[132:135]
    ds_read_b128 v[68:71], v148 offset:28672
    v_sin_f32 v175, v17
    s_nop 0
    v_pk_mul_f32 v[174:175], v[174:175], v[16:17] op_sel:[0,0] op_sel_hi:[1,0]
    v_mfma_f32_16x16x32_bf16 v[136:139], v[88:91], v[212:215], v[136:139]
    ds_read_b128 v[72:75], v148 offset:43008
    v_mul_f32 v16, 0x42800000, v10
    v_mul_f32 v17, 0x42800000, v11
    s_waitcnt lgkmcnt(8)
    v_mfma_f32_16x16x32_bf16 v[124:127], v[28:31], v[216:219], v[124:127]
    ds_read_b128 v[76:79], v149 offset:0
    v_exp_f32 v16, v16
    v_rndne_f32 v18, v17
    v_mfma_f32_16x16x32_bf16 v[128:131], v[32:35], v[216:219], v[128:131]
    ds_read_b128 v[80:83], v149 offset:14336
    v_sub_f32 v17, v17, v18
    v_cos_f32 v176, v17
    v_mfma_f32_16x16x32_bf16 v[132:135], v[36:39], v[216:219], v[132:135]
    ds_read_b128 v[84:87], v149 offset:28672
    v_sin_f32 v177, v17
    s_nop 0
    v_pk_mul_f32 v[176:177], v[176:177], v[16:17] op_sel:[0,0] op_sel_hi:[1,0]
    v_mfma_f32_16x16x32_bf16 v[136:139], v[40:43], v[216:219], v[136:139]
    ds_read_b128 v[88:91], v149 offset:43008
    s_add_u32 s13, s13, 1
    s_cmp_eq_u32 s13, 7
    s_cselect_b32 s13, 0, s13
    v_lshl_add_u32 v148, s13, 10, v152
    v_xor_b32 v149, 64, v148
    v_mul_f32 v16, v9, v10
    v_mul_f32 v17, v9, v11
    s_waitcnt lgkmcnt(8)
    v_mfma_f32_16x16x32_bf16 v[124:127], v[44:47], v[220:223], v[124:127]
    ds_read_b128 v[28:31], v148 offset:0
    v_exp_f32 v16, v16
    v_rndne_f32 v18, v17
    v_mfma_f32_16x16x32_bf16 v[128:131], v[48:51], v[220:223], v[128:131]
    ds_read_b128 v[32:35], v148 offset:14336
    v_sub_f32 v17, v17, v18
    v_cos_f32 v178, v17
    v_mfma_f32_16x16x32_bf16 v[132:135], v[52:55], v[220:223], v[132:135]
    ds_read_b128 v[36:39], v148 offset:28672
    v_sin_f32 v179, v17
    s_nop 0
    v_pk_mul_f32 v[178:179], v[178:179], v[16:17] op_sel:[0,0] op_sel_hi:[1,0]
    v_mfma_f32_16x16x32_bf16 v[136:139], v[56:59], v[220:223], v[136:139]
    ds_read_b128 v[40:43], v148 offset:43008
    v_mul_f32 v16, v8, v10
    v_mul_f32 v17, v8, v11
    s_waitcnt lgkmcnt(8)
    v_mfma_f32_16x16x32_bf16 v[124:127], v[60:63], v[224:227], v[124:127]
    ds_read_b128 v[44:47], v149 offset:0
    v_exp_f32 v16, v16
    v_rndne_f32 v18, v17
    v_mfma_f32_16x16x32_bf16 v[128:131], v[64:67], v[224:227], v[128:131]
    ds_read_b128 v[48:51], v149 offset:14336
    v_sub_f32 v17, v17, v18
    v_cos_f32 v180, v17
    v_mfma_f32_16x16x32_bf16 v[132:135], v[68:71], v[224:227], v[132:135]
    ds_read_b128 v[52:55], v149 offset:28672
    v_sin_f32 v181, v17
    s_nop 0
    v_pk_mul_f32 v[180:181], v[180:181], v[16:17] op_sel:[0,0] op_sel_hi:[1,0]
    v_mfma_f32_16x16x32_bf16 v[136:139], v[72:75], v[224:227], v[136:139]
    ds_read_b128 v[56:59], v149 offset:43008
    s_add_u32 s13, s13, 1
    s_cmp_eq_u32 s13, 7
    s_cselect_b32 s13, 0, s13
    v_lshl_add_u32 v148, s13, 10, v152
    v_xor_b32 v149, 64, v148
    v_mul_f32 v8, v6, v6
    v_fmac_f32 v8, v7, v7
    s_waitcnt lgkmcnt(8)
    v_mfma_f32_16x16x32_bf16 v[124:127], v[76:79], v[228:231], v[124:127]
    ds_read_b128 v[60:63], v148 offset:0
    v_rcp_f32 v8, v8
    v_add_f32 v12, -1.0, v172
    v_mfma_f32_16x16x32_bf16 v[128:131], v[80:83], v[228:231], v[128:131]
    ds_read_b128 v[64:67], v148 offset:14336
    v_mov_b32 v13, v173
    v_add_f32 v8, v8, v8
    v_mfma_f32_16x16x32_bf16 v[132:135], v[84:87], v[228:231], v[132:135]
    ds_read_b128 v[68:71], v148 offset:28672
    v_mul_f32 v6, v6, v8
    v_mul_f32 v7, -v7, v8
    v_mfma_f32_16x16x32_bf16 v[136:139], v[88:91], v[228:231], v[136:139]
    ds_read_b128 v[72:75], v148 offset:43008
    v_pk_mul_f32 v[182:183], v[12:13], v[6:7] op_sel:[0,0] op_sel_hi:[0,1]
    v_pk_fma_f32 v[182:183], v[12:13], v[6:7], v[182:183] op_sel:[1,1,0] op_sel_hi:[1,0,1] neg_lo:[1,0,0]
    s_waitcnt lgkmcnt(8)
    v_mfma_f32_16x16x32_bf16 v[124:127], v[28:31], v[232:235], v[124:127]
    ds_read_b128 v[76:79], v149 offset:0
    v_mfma_f32_16x16x32_bf16 v[128:131], v[32:35], v[232:235], v[128:131]
    ds_read_b128 v[80:83], v149 offset:14336
    v_mfma_f32_16x16x32_bf16 v[132:135], v[36:39], v[232:235], v[132:135]
    ds_read_b128 v[84:87], v149 offset:28672
    v_mfma_f32_16x16x32_bf16 v[136:139], v[40:43], v[232:235], v[136:139]
    ds_read_b128 v[88:91], v149 offset:43008
    s_add_u32 s13, s13, 1
    s_cmp_eq_u32 s13, 7
    s_cselect_b32 s13, 0, s13
    v_lshl_add_u32 v148, s13, 10, v152
    v_xor_b32 v149, 64, v148
    s_waitcnt lgkmcnt(8)
    v_mfma_f32_16x16x32_bf16 v[124:127], v[44:47], v[236:239], v[124:127]
    ds_read_b128 v[28:31], v148 offset:0
    v_mfma_f32_16x16x32_bf16 v[128:131], v[48:51], v[236:239], v[128:131]
    ds_read_b128 v[32:35], v148 offset:14336
    v_mfma_f32_16x16x32_bf16 v[132:135], v[52:55], v[236:239], v[132:135]
    ds_read_b128 v[36:39], v148 offset:28672
    v_mfma_f32_16x16x32_bf16 v[136:139], v[56:59], v[236:239], v[136:139]
    ds_read_b128 v[40:43], v148 offset:43008
    s_waitcnt lgkmcnt(8)
    v_mfma_f32_16x16x32_bf16 v[124:127], v[60:63], v[240:243], v[124:127]
    ds_read_b128 v[44:47], v149 offset:0
    v_mfma_f32_16x16x32_bf16 v[128:131], v[64:67], v[240:243], v[128:131]
    ds_read_b128 v[48:51], v149 offset:14336
    v_mfma_f32_16x16x32_bf16 v[132:135], v[68:71], v[240:243], v[132:135]
    ds_read_b128 v[52:55], v149 offset:28672
    v_mfma_f32_16x16x32_bf16 v[136:139], v[72:75], v[240:243], v[136:139]
    ds_read_b128 v[56:59], v149 offset:43008
    s_waitcnt lgkmcnt(8)
    v_mfma_f32_16x16x32_bf16 v[124:127], v[76:79], v[244:247], v[124:127]
    v_mfma_f32_16x16x32_bf16 v[128:131], v[80:83], v[244:247], v[128:131]
    v_mfma_f32_16x16x32_bf16 v[132:135], v[84:87], v[244:247], v[132:135]
    v_mfma_f32_16x16x32_bf16 v[136:139], v[88:91], v[244:247], v[136:139]
    s_waitcnt lgkmcnt(4)
    v_mfma_f32_16x16x32_bf16 v[124:127], v[28:31], v[248:251], v[124:127]
    v_mfma_f32_16x16x32_bf16 v[128:131], v[32:35], v[248:251], v[128:131]
    v_mfma_f32_16x16x32_bf16 v[132:135], v[36:39], v[248:251], v[132:135]
    v_mfma_f32_16x16x32_bf16 v[136:139], v[40:43], v[248:251], v[136:139]
    s_waitcnt lgkmcnt(0)
    v_mfma_f32_16x16x32_bf16 v[124:127], v[44:47], v[252:255], v[124:127]
    v_mfma_f32_16x16x32_bf16 v[128:131], v[48:51], v[252:255], v[128:131]
    v_mfma_f32_16x16x32_bf16 v[132:135], v[52:55], v[252:255], v[132:135]
    v_mfma_f32_16x16x32_bf16 v[136:139], v[56:59], v[252:255], v[136:139]
    s_nop 4
    v_mov_b32 v156, v124
    s_nop 0
    v_mov_b32 v157, v132
    v_mov_b32 v158, v125
    v_mov_b32 v159, v133
    v_mov_b32 v160, v126
    v_mov_b32 v161, v134
    v_mov_b32 v162, v127
    v_mov_b32 v163, v135
    v_mov_b32 v164, v128
    v_mov_b32 v165, v136
    v_mov_b32 v166, v129
    v_mov_b32 v167, v137
    v_mov_b32 v168, v130
    v_mov_b32 v169, v138
    v_mov_b32 v170, v131
    v_mov_b32 v171, v139
    v_mov_b32_dpp v156, v132 row_ror:8 row_mask:0xf bank_mask:0xc
    v_mov_b32_dpp v157, v124 row_ror:8 row_mask:0xf bank_mask:0x3
    v_mov_b32_dpp v158, v133 row_ror:8 row_mask:0xf bank_mask:0xc
    v_mov_b32_dpp v159, v125 row_ror:8 row_mask:0xf bank_mask:0x3
    v_mov_b32_dpp v160, v134 row_ror:8 row_mask:0xf bank_mask:0xc
    v_mov_b32_dpp v161, v126 row_ror:8 row_mask:0xf bank_mask:0x3
    v_mov_b32_dpp v162, v135 row_ror:8 row_mask:0xf bank_mask:0xc
    v_mov_b32_dpp v163, v127 row_ror:8 row_mask:0xf bank_mask:0x3
    v_mov_b32_dpp v164, v136 row_ror:8 row_mask:0xf bank_mask:0xc
    v_mov_b32_dpp v165, v128 row_ror:8 row_mask:0xf bank_mask:0x3
    v_mov_b32_dpp v166, v137 row_ror:8 row_mask:0xf bank_mask:0xc
    v_mov_b32_dpp v167, v129 row_ror:8 row_mask:0xf bank_mask:0x3
    v_mov_b32_dpp v168, v138 row_ror:8 row_mask:0xf bank_mask:0xc
    v_mov_b32_dpp v169, v130 row_ror:8 row_mask:0xf bank_mask:0x3
    v_mov_b32_dpp v170, v139 row_ror:8 row_mask:0xf bank_mask:0xc
    v_mov_b32_dpp v171, v131 row_ror:8 row_mask:0xf bank_mask:0x3
    v_pk_fma_f32 v[12:13], v[156:157], v[172:173], v[158:159] op_sel:[0,0,0] op_sel_hi:[0,1,1]
    v_pk_fma_f32 v[12:13], v[156:157], v[172:173], v[12:13] op_sel:[1,1,0] op_sel_hi:[1,0,1] neg_lo:[1,0,0]
    v_pk_fma_f32 v[10:11], v[12:13], v[172:173], v[160:161] op_sel:[0,0,0] op_sel_hi:[0,1,1]
    v_pk_fma_f32 v[10:11], v[12:13], v[172:173], v[10:11] op_sel:[1,1,0] op_sel_hi:[1,0,1] neg_lo:[1,0,0]
    v_pk_fma_f32 v[12:13], v[10:11], v[172:173], v[162:163] op_sel:[0,0,0] op_sel_hi:[0,1,1]
    v_pk_fma_f32 v[12:13], v[10:11], v[172:173], v[12:13] op_sel:[1,1,0] op_sel_hi:[1,0,1] neg_lo:[1,0,0]
    v_pk_fma_f32 v[10:11], v[12:13], v[172:173], v[164:165] op_sel:[0,0,0] op_sel_hi:[0,1,1]
    v_pk_fma_f32 v[10:11], v[12:13], v[172:173], v[10:11] op_sel:[1,1,0] op_sel_hi:[1,0,1] neg_lo:[1,0,0]
    v_pk_fma_f32 v[12:13], v[10:11], v[172:173], v[166:167] op_sel:[0,0,0] op_sel_hi:[0,1,1]
    v_pk_fma_f32 v[12:13], v[10:11], v[172:173], v[12:13] op_sel:[1,1,0] op_sel_hi:[1,0,1] neg_lo:[1,0,0]
    v_pk_fma_f32 v[10:11], v[12:13], v[172:173], v[168:169] op_sel:[0,0,0] op_sel_hi:[0,1,1]
    v_pk_fma_f32 v[10:11], v[12:13], v[172:173], v[10:11] op_sel:[1,1,0] op_sel_hi:[1,0,1] neg_lo:[1,0,0]
    v_pk_fma_f32 v[12:13], v[10:11], v[172:173], v[170:171] op_sel:[0,0,0] op_sel_hi:[0,1,1]
    v_pk_fma_f32 v[12:13], v[10:11], v[172:173], v[12:13] op_sel:[1,1,0] op_sel_hi:[1,0,1] neg_lo:[1,0,0]
    ds_write_b64 v95, v[12:13]
    ds_read_b128 v[16:19], v93 offset:0
    ds_read_b128 v[20:23], v93 offset:16
    ds_read_b128 v[24:27], v93 offset:32
    ds_read_b128 v[28:31], v93 offset:48
    v_mov_b32 v253, v101
    v_mov_b32 v152, v123
    v_mov_b32 v4, v104
    v_mov_b32 v5, v105
    v_mov_b32 v6, v106
    v_mov_b32 v7, v107
    s_waitcnt lgkmcnt(0)
    v_cmp_eq_u32 vcc, 1, v94
    v_pk_fma_f32 v[12:13], v[16:17], v[174:175], v[18:19] op_sel:[0,0,0] op_sel_hi:[0,1,1]
    v_pk_fma_f32 v[12:13], v[16:17], v[174:175], v[12:13] op_sel:[1,1,0] op_sel_hi:[1,0,1] neg_lo:[1,0,0]
    v_cndmask_b32 v154, v154, v16, vcc
    v_cndmask_b32 v155, v155, v17, vcc
    v_cmp_eq_u32 vcc, 2, v94
    v_pk_fma_f32 v[10:11], v[12:13], v[174:175], v[20:21] op_sel:[0,0,0] op_sel_hi:[0,1,1]
    v_pk_fma_f32 v[10:11], v[12:13], v[174:175], v[10:11] op_sel:[1,1,0] op_sel_hi:[1,0,1] neg_lo:[1,0,0]
    v_cndmask_b32 v154, v154, v12, vcc
    v_cndmask_b32 v155, v155, v13, vcc
    v_cmp_eq_u32 vcc, 3, v94
    v_pk_fma_f32 v[12:13], v[10:11], v[174:175], v[22:23] op_sel:[0,0,0] op_sel_hi:[0,1,1]
    v_pk_fma_f32 v[12:13], v[10:11], v[174:175], v[12:13] op_sel:[1,1,0] op_sel_hi:[1,0,1] neg_lo:[1,0,0]
    v_cndmask_b32 v154, v154, v10, vcc
    v_cndmask_b32 v155, v155, v11, vcc
    v_cmp_eq_u32 vcc, 4, v94
    v_pk_fma_f32 v[10:11], v[12:13], v[174:175], v[24:25] op_sel:[0,0,0] op_sel_hi:[0,1,1]
    v_pk_fma_f32 v[10:11], v[12:13], v[174:175], v[10:11] op_sel:[1,1,0] op_sel_hi:[1,0,1] neg_lo:[1,0,0]
    v_cndmask_b32 v154, v154, v12, vcc
    v_cndmask_b32 v155, v155, v13, vcc
    v_cmp_eq_u32 vcc, 5, v94
    v_pk_fma_f32 v[12:13], v[10:11], v[174:175], v[26:27] op_sel:[0,0,0] op_sel_hi:[0,1,1]
    v_pk_fma_f32 v[12:13], v[10:11], v[174:175], v[12:13] op_sel:[1,1,0] op_sel_hi:[1,0,1] neg_lo:[1,0,0]
    v_cndmask_b32 v154, v154, v10, vcc
    v_cndmask_b32 v155, v155, v11, vcc
    v_cmp_eq_u32 vcc, 6, v94
    v_pk_fma_f32 v[10:11], v[12:13], v[174:175], v[28:29] op_sel:[0,0,0] op_sel_hi:[0,1,1]
    v_pk_fma_f32 v[10:11], v[12:13], v[174:175], v[10:11] op_sel:[1,1,0] op_sel_hi:[1,0,1] neg_lo:[1,0,0]
    v_cndmask_b32 v154, v154, v12, vcc
    v_cndmask_b32 v155, v155, v13, vcc
    v_cmp_eq_u32 vcc, 7, v94
    v_pk_fma_f32 v[12:13], v[10:11], v[174:175], v[30:31] op_sel:[0,0,0] op_sel_hi:[0,1,1]
    v_pk_fma_f32 v[12:13], v[10:11], v[174:175], v[12:13] op_sel:[1,1,0] op_sel_hi:[1,0,1] neg_lo:[1,0,0]
    v_cndmask_b32 v154, v154, v10, vcc
    v_cndmask_b32 v155, v155, v11, vcc
    v_mov_b32 v16, v12
    v_mov_b32 v17, s31
    v_mov_b32 v18, v13
    v_mov_b32 v19, s31
    s_mov_b64 exec, 0xff
    buffer_store_dwordx4 v[16:19], v96, s[96:99], 0 offen sc1
    s_mov_b64 exec, -1
    s_setprio 3
    s_barrier
    ds_read2_b64 v[12:15], v112 offset0:0 offset1:1
    ds_read2_b64 v[16:19], v113 offset0:0 offset1:1
    ds_read2_b64 v[20:23], v114 offset0:0 offset1:1
    ds_read2_b64 v[24:27], v115 offset0:0 offset1:1
    s_mov_b32 s7, 0
    s_waitcnt vmcnt(1)
LTG0:
    v_xor_b32 v8, s31, v141
    v_xor_b32 v9, s31, v143
    v_or_b32 v8, v8, v9
    v_xor_b32 v9, s31, v145
    v_or_b32 v8, v8, v9
    v_xor_b32 v9, s31, v147
    v_or_b32 v8, v8, v9
    v_cmp_ne_u32 vcc, 0, v8
    s_nop 4
    s_cbranch_vccz LTD0
    s_add_u32 s7, s7, 1
    s_cmp_gt_u32 s7, 0x40000
    s_cbranch_scc1 LTD0
    s_sleep 2
    global_load_dwordx4 v[140:143], v151, s[58:59] sc1
    global_load_dwordx4 v[144:147], v151, s[58:59] offset:1024 sc1
    s_waitcnt vmcnt(0)
    s_branch LTG0
LTD0:
    v_perm_b32 v30, v142, v140, s20
    v_perm_b32 v31, v142, v140, s21
    ds_write_b32 v102, v30 offset:256
    ds_write_b32 v102, v31 offset:8832
    ds_write_b16 v102, v142 offset:4542
    ds_write_b16 v102, v140 offset:4544
    ds_write_b16_d16_hi v102, v142 offset:13118
    ds_write_b16_d16_hi v102, v140 offset:13120
    v_perm_b32 v32, v146, v144, s20
    v_perm_b32 v33, v146, v144, s21
    ds_write_b32 v102, v32 offset:0
    ds_write_b32 v102, v33 offset:8576
    ds_write_b16 v102, v146 offset:4286
    ds_write_b16 v102, v144 offset:4288
    ds_write_b16_d16_hi v102, v146 offset:12862
    ds_write_b16_d16_hi v102, v144 offset:12864
    s_waitcnt lgkmcnt(12)
    v_pk_add_f32 v[12:13], v[12:13], v[16:17]
    v_pk_add_f32 v[14:15], v[14:15], v[18:19]
    v_pk_add_f32 v[20:21], v[20:21], v[24:25]
    v_pk_add_f32 v[22:23], v[22:23], v[26:27]
    v_pk_add_f32 v[12:13], v[12:13], v[20:21]
    v_pk_add_f32 v[14:15], v[14:15], v[22:23]
    v_cvt_pk_bf16_f32 v16, v12, v12
    v_cvt_pk_bf16_f32 v18, v12, v13
    v_cvt_pk_bf16_f32 v19, v13, v13
    v_cvt_pk_bf16_f32 v22, v14, v14
    s_cmp_eq_u32 s18, 0
    s_nop 0
    s_cbranch_scc1 LX0
    s_cmp_eq_u32 s18, 1
    s_cbranch_scc1 LX1
    s_cmp_eq_u32 s18, 2
    s_cbranch_scc1 LX2
    v_mov_b32 v17, v16
    v_mov_b32 v20, v19
    v_mov_b32 v21, v19
    v_mov_b32 v23, v22
    ds_write_b128 v116, v[16:19]
    ds_write_b128 v116, v[20:23] offset:16
    s_branch LX3
LX0:
    v_cvt_pk_bf16_f32 v19, v14, v15
    ds_write_b64 v116, v[18:19]
    s_nop 0
    s_branch LX3
LX1:
    v_cvt_pk_bf16_f32 v17, v13, v14
    ds_write_b64 v116, v[16:17]
    s_nop 0
    s_branch LX3
LX2:
    v_mov_b32 v17, v18
    v_mov_b32 v18, v19
    v_mov_b32 v19, v22
    ds_write_b128 v116, v[16:19]
LX3:
    v_mov_b32 v20, 0
    v_mov_b32 v21, 0
    v_mov_b32 v22, 0
    v_mov_b32 v23, 0
    s_cmp_lg_u32 s3, 0
    s_nop 0
    s_cbranch_scc1 LNZ
    v_lshrrev_b32 v16, 5, v1
    v_mul_u32_u24 v16, 4672, v16
    v_and_b32 v17, 31, v1
    v_min_u32 v17, 29, v17
    v_lshl_add_u32 v16, v17, 4, v16
    v_add_u32 v16, 131840, v16
    v_lshrrev_b32 v17, 1, v1
    v_and_b32 v17, 3, v17
    v_mul_u32_u24 v17, 4288, v17
    v_and_b32 v18, 1, v1
    v_lshl_add_u32 v18, v18, 4, v17
    v_add_u32 v18, 118784, v18
    ds_write_b128 v16, v[20:23]
    ds_write_b128 v18, v[20:23]
    v_mov_b32 v19, 123070
    ds_write_b16 v19, v20
    ds_write_b16 v19, v20 offset:8576
LNZ:
    s_waitcnt lgkmcnt(0)
    s_barrier
    s_bitcmp1_b32 s3, 0
    s_cbranch_scc1 LCB0
    ds_read2_b32 v[8:9], v4 offset0:176 offset1:177
    ds_read2_b32 v[10:11], v4 offset0:178 offset1:179
    ds_read_b128 v[40:43], v152 offset:192
    ds_read2_b32 v[12:13], v4 offset0:48 offset1:49
    ds_read2_b32 v[14:15], v4 offset0:50 offset1:51
    ds_read_b128 v[44:47], v152 offset:704
    ds_read2_b32 v[16:17], v5 offset0:176 offset1:177
    ds_read2_b32 v[18:19], v5 offset0:178 offset1:179
    ds_read_b128 v[48:51], v152 offset:1216
    ds_read2_b32 v[20:21], v5 offset0:48 offset1:49
    ds_read2_b32 v[22:23], v5 offset0:50 offset1:51
    ds_read_b128 v[52:55], v152 offset:1728
    ds_read2_b32 v[24:25], v6 offset0:176 offset1:177
    ds_read2_b32 v[26:27], v6 offset0:178 offset1:179
    ds_read_b128 v[56:59], v152 offset:2240
    ds_read2_b32 v[28:29], v6 offset0:48 offset1:49
    ds_read2_b32 v[30:31], v6 offset0:50 offset1:51
    ds_read_b128 v[60:63], v152 offset:2752
    ds_read2_b32 v[32:33], v7 offset0:176 offset1:177
    ds_read2_b32 v[34:35], v7 offset0:178 offset1:179
    ds_read_b128 v[64:67], v152 offset:3264
    ds_read2_b32 v[36:37], v7 offset0:48 offset1:49
    ds_read2_b32 v[38:39], v7 offset0:50 offset1:51
    ds_read_b128 v[68:71], v152 offset:3776
    s_waitcnt lgkmcnt(0)
    v_mfma_f32_16x16x32_bf16 v[136:139], v[8:11], v[68:71], 0
    ds_read2_b32 v[72:73], v4 offset0:160 offset1:161
    ds_read2_b32 v[74:75], v4 offset0:162 offset1:163
    v_mfma_f32_16x16x32_bf16 v[140:143], v[8:11], v[64:67], 0
    ds_read_b128 v[104:107], v152 offset:128
    ds_read2_b32 v[76:77], v4 offset0:32 offset1:33
    v_mfma_f32_16x16x32_bf16 v[144:147], v[8:11], v[44:47], 0
    ds_read2_b32 v[78:79], v4 offset0:34 offset1:35
    ds_read_b128 v[108:111], v152 offset:640
    v_mfma_f32_16x16x32_bf16 v[148:151], v[8:11], v[40:43], 0
    buffer_load_dwordx4 v[204:207], v184, s[96:99], 0 offen sc1
    buffer_load_dwordx4 v[208:211], v185, s[96:99], 0 offen sc1
    buffer_load_dwordx4 v[212:215], v186, s[96:99], 0 offen sc1
    buffer_load_dwordx4 v[216:219], v187, s[96:99], 0 offen sc1
    ds_read2_b32 v[80:81], v5 offset0:160 offset1:161
    ds_read2_b32 v[82:83], v5 offset0:162 offset1:163
    v_mfma_f32_16x16x32_bf16 v[136:139], v[12:15], v[64:67], v[136:139]
    ds_read_b128 v[112:115], v152 offset:1152
    ds_read2_b32 v[84:85], v5 offset0:32 offset1:33
    v_mfma_f32_16x16x32_bf16 v[140:143], v[12:15], v[60:63], v[140:143]
    ds_read2_b32 v[86:87], v5 offset0:34 offset1:35
    ds_read_b128 v[116:119], v152 offset:1664
    v_mfma_f32_16x16x32_bf16 v[144:147], v[12:15], v[40:43], v[144:147]
    ds_read2_b32 v[88:89], v6 offset0:160 offset1:161
    ds_read2_b32 v[90:91], v6 offset0:162 offset1:163
    v_mfma_f32_16x16x32_bf16 v[136:139], v[16:19], v[60:63], v[136:139]
    ds_read_b128 v[120:123], v152 offset:2176
    ds_read2_b32 v[92:93], v6 offset0:32 offset1:33
    v_mfma_f32_16x16x32_bf16 v[140:143], v[16:19], v[56:59], v[140:143]
    ds_read2_b32 v[94:95], v6 offset0:34 offset1:35
    ds_read_b128 v[124:127], v152 offset:2688
    v_mfma_f32_16x16x32_bf16 v[136:139], v[20:23], v[56:59], v[136:139]
    ds_read2_b32 v[96:97], v7 offset0:160 offset1:161
    ds_read2_b32 v[98:99], v7 offset0:162 offset1:163
    v_mfma_f32_16x16x32_bf16 v[140:143], v[20:23], v[52:55], v[140:143]
    ds_read_b128 v[128:131], v152 offset:3200
    ds_read2_b32 v[100:101], v7 offset0:32 offset1:33
    v_mfma_f32_16x16x32_bf16 v[136:139], v[24:27], v[52:55], v[136:139]
    ds_read2_b32 v[102:103], v7 offset0:34 offset1:35
    ds_read_b128 v[132:135], v152 offset:3712
    v_mfma_f32_16x16x32_bf16 v[140:143], v[24:27], v[48:51], v[140:143]
    v_mfma_f32_16x16x32_bf16 v[136:139], v[28:31], v[48:51], v[136:139]
    v_mfma_f32_16x16x32_bf16 v[140:143], v[28:31], v[44:47], v[140:143]
    v_mfma_f32_16x16x32_bf16 v[136:139], v[32:35], v[44:47], v[136:139]
    v_mfma_f32_16x16x32_bf16 v[140:143], v[32:35], v[40:43], v[140:143]
    v_mfma_f32_16x16x32_bf16 v[136:139], v[36:39], v[40:43], v[136:139]
    s_nop 7
    s_branch LCE0
LCB0:
    ds_read2_b32 v[8:9], v4 offset0:176 offset1:177
    ds_read2_b32 v[10:11], v4 offset0:178 offset1:179
    ds_read_b128 v[40:43], v152 offset:192
    ds_read2_b32 v[12:13], v4 offset0:48 offset1:49
    ds_read2_b32 v[14:15], v4 offset0:50 offset1:51
    ds_read_b128 v[44:47], v152 offset:704
    ds_read2_b32 v[16:17], v5 offset0:176 offset1:177
    ds_read2_b32 v[18:19], v5 offset0:178 offset1:179
    ds_read_b128 v[48:51], v152 offset:1216
    ds_read2_b32 v[20:21], v5 offset0:48 offset1:49
    ds_read2_b32 v[22:23], v5 offset0:50 offset1:51
    ds_read_b128 v[52:55], v152 offset:1728
    ds_read2_b32 v[24:25], v6 offset0:176 offset1:177
    ds_read2_b32 v[26:27], v6 offset0:178 offset1:179
    ds_read_b128 v[56:59], v152 offset:2240
    ds_read2_b32 v[28:29], v6 offset0:48 offset1:49
    ds_read2_b32 v[30:31], v6 offset0:50 offset1:51
    ds_read_b128 v[60:63], v152 offset:2752
    s_waitcnt lgkmcnt(0)
    v_mfma_f32_16x16x32_bf16 v[136:139], v[8:11], v[60:63], 0
    ds_read2_b32 v[72:73], v4 offset0:160 offset1:161
    ds_read2_b32 v[74:75], v4 offset0:162 offset1:163
    v_mfma_f32_16x16x32_bf16 v[140:143], v[8:11], v[56:59], 0
    ds_read_b128 v[104:107], v152 offset:128
    ds_read2_b32 v[76:77], v4 offset0:32 offset1:33
    v_mfma_f32_16x16x32_bf16 v[144:147], v[8:11], v[52:55], 0
    ds_read2_b32 v[78:79], v4 offset0:34 offset1:35
    ds_read_b128 v[108:111], v152 offset:640
    v_mfma_f32_16x16x32_bf16 v[148:151], v[8:11], v[48:51], 0
    buffer_load_dwordx4 v[204:207], v184, s[96:99], 0 offen sc1
    buffer_load_dwordx4 v[208:211], v185, s[96:99], 0 offen sc1
    buffer_load_dwordx4 v[212:215], v186, s[96:99], 0 offen sc1
    buffer_load_dwordx4 v[216:219], v187, s[96:99], 0 offen sc1
    ds_read2_b32 v[80:81], v5 offset0:160 offset1:161
    ds_read2_b32 v[82:83], v5 offset0:162 offset1:163
    v_mfma_f32_16x16x32_bf16 v[136:139], v[12:15], v[56:59], v[136:139]
    ds_read_b128 v[112:115], v152 offset:1152
    ds_read2_b32 v[84:85], v5 offset0:32 offset1:33
    v_mfma_f32_16x16x32_bf16 v[140:143], v[12:15], v[52:55], v[140:143]
    ds_read2_b32 v[86:87], v5 offset0:34 offset1:35
    ds_read_b128 v[116:119], v152 offset:1664
    v_mfma_f32_16x16x32_bf16 v[144:147], v[12:15], v[48:51], v[144:147]
    ds_read2_b32 v[88:89], v6 offset0:160 offset1:161
    ds_read2_b32 v[90:91], v6 offset0:162 offset1:163
    v_mfma_f32_16x16x32_bf16 v[148:151], v[12:15], v[44:47], v[148:151]
    ds_read_b128 v[120:123], v152 offset:2176
    ds_read2_b32 v[92:93], v6 offset0:32 offset1:33
    v_mfma_f32_16x16x32_bf16 v[136:139], v[16:19], v[52:55], v[136:139]
    ds_read2_b32 v[94:95], v6 offset0:34 offset1:35
    ds_read_b128 v[124:127], v152 offset:2688
    v_mfma_f32_16x16x32_bf16 v[140:143], v[16:19], v[48:51], v[140:143]
    v_mfma_f32_16x16x32_bf16 v[144:147], v[16:19], v[44:47], v[144:147]
    v_mfma_f32_16x16x32_bf16 v[148:151], v[16:19], v[40:43], v[148:151]
    v_mfma_f32_16x16x32_bf16 v[136:139], v[20:23], v[48:51], v[136:139]
    v_mfma_f32_16x16x32_bf16 v[140:143], v[20:23], v[44:47], v[140:143]
    v_mfma_f32_16x16x32_bf16 v[144:147], v[20:23], v[40:43], v[144:147]
    v_mfma_f32_16x16x32_bf16 v[136:139], v[24:27], v[44:47], v[136:139]
    v_mfma_f32_16x16x32_bf16 v[140:143], v[24:27], v[40:43], v[140:143]
    v_mfma_f32_16x16x32_bf16 v[136:139], v[28:31], v[40:43], v[136:139]
    s_nop 7
LCE0:
    s_mov_b32 s7, 0
    s_waitcnt vmcnt(0)
LTG1:
    v_xor_b32 v202, v188, v205
    v_xor_b32 v203, v188, v207
    v_or_b32 v202, v202, v203
    v_xor_b32 v203, v189, v209
    v_or_b32 v202, v202, v203
    v_xor_b32 v203, v189, v211
    v_or_b32 v202, v202, v203
    v_xor_b32 v203, v190, v213
    v_or_b32 v202, v202, v203
    v_xor_b32 v203, v190, v215
    v_or_b32 v202, v202, v203
    v_xor_b32 v203, v191, v217
    v_or_b32 v202, v202, v203
    v_xor_b32 v203, v191, v219
    v_or_b32 v202, v202, v203
    v_cmp_ne_u32 vcc, 0, v202
    s_nop 4
    s_cbranch_vccz LTD1
    s_add_u32 s7, s7, 1
    s_cmp_gt_u32 s7, 0x40000
    s_cbranch_scc1 LTD1
    s_sleep 2
    buffer_load_dwordx4 v[204:207], v184, s[96:99], 0 offen sc1
    buffer_load_dwordx4 v[208:211], v185, s[96:99], 0 offen sc1
    buffer_load_dwordx4 v[212:215], v186, s[96:99], 0 offen sc1
    buffer_load_dwordx4 v[216:219], v187, s[96:99], 0 offen sc1
    s_waitcnt vmcnt(0)
    s_branch LTG1
LTD1:
    v_mov_b32 v205, v206
    v_mov_b32 v209, v210
    v_mov_b32 v213, v214
    v_mov_b32 v217, v218
    v_pk_fma_f32 v[220:221], v[216:217], v[176:177], v[212:213] op_sel:[0,0,0] op_sel_hi:[0,1,1]
    v_pk_fma_f32 v[220:221], v[216:217], v[176:177], v[220:221] op_sel:[1,1,0] op_sel_hi:[1,0,1] neg_lo:[1,0,0]
    v_pk_fma_f32 v[222:223], v[220:221], v[176:177], v[208:209] op_sel:[0,0,0] op_sel_hi:[0,1,1]
    v_pk_fma_f32 v[222:223], v[220:221], v[176:177], v[222:223] op_sel:[1,1,0] op_sel_hi:[1,0,1] neg_lo:[1,0,0]
    v_pk_fma_f32 v[220:221], v[222:223], v[176:177], v[204:205] op_sel:[0,0,0] op_sel_hi:[0,1,1]
    v_pk_fma_f32 v[220:221], v[222:223], v[176:177], v[220:221] op_sel:[1,1,0] op_sel_hi:[1,0,1] neg_lo:[1,0,0]
    v_pk_mul_f32 v[216:217], v[220:221], v[178:179] op_sel:[0,0] op_sel_hi:[0,1]
    v_pk_fma_f32 v[216:217], v[220:221], v[178:179], v[216:217] op_sel:[1,1,0] op_sel_hi:[1,0,1] neg_lo:[1,0,0]
    ds_write_b64 v193, v[216:217]
    ds_read_b128 v[220:223], v192 offset:0
    ds_read_b128 v[224:227], v192 offset:16
    ds_read_b128 v[228:231], v192 offset:32
    ds_read_b128 v[232:235], v192 offset:48
    s_waitcnt lgkmcnt(0)
    v_pk_add_f32 v[220:221], v[220:221], v[222:223]
    v_pk_add_f32 v[224:225], v[224:225], v[226:227]
    v_pk_add_f32 v[228:229], v[228:229], v[230:231]
    v_pk_add_f32 v[232:233], v[232:233], v[234:235]
    v_pk_add_f32 v[220:221], v[220:221], v[224:225]
    v_pk_add_f32 v[228:229], v[228:229], v[232:233]
    v_pk_add_f32 v[220:221], v[220:221], v[228:229]
    v_pk_fma_f32 v[218:219], v[220:221], v[180:181], v[154:155] op_sel:[0,0,0] op_sel_hi:[0,1,1]
    v_pk_fma_f32 v[218:219], v[220:221], v[180:181], v[218:219] op_sel:[1,1,0] op_sel_hi:[1,0,1] neg_lo:[1,0,0]
    v_pk_fma_f32 v[156:157], v[218:219], v[172:173], v[156:157] op_sel:[0,0,0] op_sel_hi:[0,1,1]
    v_pk_fma_f32 v[156:157], v[218:219], v[172:173], v[156:157] op_sel:[1,1,0] op_sel_hi:[1,0,1] neg_lo:[1,0,0]
    v_pk_mul_f32 v[220:221], v[156:157], v[182:183] op_sel:[0,0] op_sel_hi:[0,1]
    v_pk_fma_f32 v[220:221], v[156:157], v[182:183], v[220:221] op_sel:[1,1,0] op_sel_hi:[1,0,1] neg_lo:[1,0,0]
    v_pk_fma_f32 v[158:159], v[156:157], v[172:173], v[158:159] op_sel:[0,0,0] op_sel_hi:[0,1,1]
    v_pk_fma_f32 v[158:159], v[156:157], v[172:173], v[158:159] op_sel:[1,1,0] op_sel_hi:[1,0,1] neg_lo:[1,0,0]
    v_pk_mul_f32 v[222:223], v[158:159], v[182:183] op_sel:[0,0] op_sel_hi:[0,1]
    v_pk_fma_f32 v[222:223], v[158:159], v[182:183], v[222:223] op_sel:[1,1,0] op_sel_hi:[1,0,1] neg_lo:[1,0,0]
    v_pk_fma_f32 v[160:161], v[158:159], v[172:173], v[160:161] op_sel:[0,0,0] op_sel_hi:[0,1,1]
    v_pk_fma_f32 v[160:161], v[158:159], v[172:173], v[160:161] op_sel:[1,1,0] op_sel_hi:[1,0,1] neg_lo:[1,0,0]
    v_pk_mul_f32 v[224:225], v[160:161], v[182:183] op_sel:[0,0] op_sel_hi:[0,1]
    v_pk_fma_f32 v[224:225], v[160:161], v[182:183], v[224:225] op_sel:[1,1,0] op_sel_hi:[1,0,1] neg_lo:[1,0,0]
    v_pk_fma_f32 v[162:163], v[160:161], v[172:173], v[162:163] op_sel:[0,0,0] op_sel_hi:[0,1,1]
    v_pk_fma_f32 v[162:163], v[160:161], v[172:173], v[162:163] op_sel:[1,1,0] op_sel_hi:[1,0,1] neg_lo:[1,0,0]
    v_pk_mul_f32 v[226:227], v[162:163], v[182:183] op_sel:[0,0] op_sel_hi:[0,1]
    v_pk_fma_f32 v[226:227], v[162:163], v[182:183], v[226:227] op_sel:[1,1,0] op_sel_hi:[1,0,1] neg_lo:[1,0,0]
    v_pk_fma_f32 v[164:165], v[162:163], v[172:173], v[164:165] op_sel:[0,0,0] op_sel_hi:[0,1,1]
    v_pk_fma_f32 v[164:165], v[162:163], v[172:173], v[164:165] op_sel:[1,1,0] op_sel_hi:[1,0,1] neg_lo:[1,0,0]
    v_pk_mul_f32 v[228:229], v[164:165], v[182:183] op_sel:[0,0] op_sel_hi:[0,1]
    v_pk_fma_f32 v[228:229], v[164:165], v[182:183], v[228:229] op_sel:[1,1,0] op_sel_hi:[1,0,1] neg_lo:[1,0,0]
    v_pk_fma_f32 v[166:167], v[164:165], v[172:173], v[166:167] op_sel:[0,0,0] op_sel_hi:[0,1,1]
    v_pk_fma_f32 v[166:167], v[164:165], v[172:173], v[166:167] op_sel:[1,1,0] op_sel_hi:[1,0,1] neg_lo:[1,0,0]
    v_pk_mul_f32 v[230:231], v[166:167], v[182:183] op_sel:[0,0] op_sel_hi:[0,1]
    v_pk_fma_f32 v[230:231], v[166:167], v[182:183], v[230:231] op_sel:[1,1,0] op_sel_hi:[1,0,1] neg_lo:[1,0,0]
    v_pk_fma_f32 v[168:169], v[166:167], v[172:173], v[168:169] op_sel:[0,0,0] op_sel_hi:[0,1,1]
    v_pk_fma_f32 v[168:169], v[166:167], v[172:173], v[168:169] op_sel:[1,1,0] op_sel_hi:[1,0,1] neg_lo:[1,0,0]
    v_pk_mul_f32 v[232:233], v[168:169], v[182:183] op_sel:[0,0] op_sel_hi:[0,1]
    v_pk_fma_f32 v[232:233], v[168:169], v[182:183], v[232:233] op_sel:[1,1,0] op_sel_hi:[1,0,1] neg_lo:[1,0,0]
    v_pk_fma_f32 v[170:171], v[168:169], v[172:173], v[170:171] op_sel:[0,0,0] op_sel_hi:[0,1,1]
    v_pk_fma_f32 v[170:171], v[168:169], v[172:173], v[170:171] op_sel:[1,1,0] op_sel_hi:[1,0,1] neg_lo:[1,0,0]
    v_pk_mul_f32 v[234:235], v[170:171], v[182:183] op_sel:[0,0] op_sel_hi:[0,1]
    v_pk_fma_f32 v[234:235], v[170:171], v[182:183], v[234:235] op_sel:[1,1,0] op_sel_hi:[1,0,1] neg_lo:[1,0,0]
    v_cvt_pk_bf16_f32 v236, v220, v222
    v_cvt_pk_bf16_f32 v240, -v221, -v223
    v_cvt_pk_bf16_f32 v237, v224, v226
    v_cvt_pk_bf16_f32 v241, -v225, -v227
    v_cvt_pk_bf16_f32 v238, v228, v230
    v_cvt_pk_bf16_f32 v242, -v229, -v231
    v_cvt_pk_bf16_f32 v239, v232, v234
    v_cvt_pk_bf16_f32 v243, -v233, -v235
    ds_write_b128 v194, v[236:239]
    ds_write_b128 v194, v[240:243] offset:1152
    ds_read_b64_tr_b16 v[244:245], v195 offset:0
    ds_read_b64_tr_b16 v[246:247], v195 offset:576
    ds_read_b64_tr_b16 v[248:249], v195 offset:1152
    ds_read_b64_tr_b16 v[250:251], v195 offset:1728
    s_waitcnt lgkmcnt(0)
    global_store_dwordx4 v196, v[244:247], s[58:59] sc1
    global_store_dwordx4 v197, v[248:251], s[58:59] sc1
    v_mov_b32 v200, 161792
    v_mov_b32 v201, 1
    s_lshl_b32 s7, s4, 7
    s_add_u32 s7, s7, 12648448
    v_lshl_add_u32 v202, v1, 2, s7
    v_mov_b32 v203, s31
    s_mov_b64 exec, 1
    s_waitcnt vmcnt(0)
    ds_add_rtn_u32 v201, v200, v201
    s_waitcnt lgkmcnt(0)
    v_readfirstlane_b32 s7, v201
    s_mov_b64 exec, -1
    s_cmp_lg_u32 s7, 7
    s_nop 2
    s_cbranch_scc1 LNF2
    s_mov_b32 exec_hi, 0
    global_store_dword v202, v203, s[58:59] sc1
    s_mov_b64 exec, -1
LNF2:
    s_setprio 0
    s_mul_i32 s7, s5, 896
    s_add_u32 s7, s7, 12648448
    v_min_u32 v156, 6, v1
    v_lshl_add_u32 v156, v156, 7, s7
    s_lshl_b32 s7, s5, 2
    s_add_u32 s7, s7, s100
    s_mul_i32 s7, s7, 28
    s_mul_i32 s61, s101, 14
    s_add_u32 s7, s7, s61
    s_lshl_b32 s7, s7, 10
    s_add_u32 s7, s7, 266240
    v_lshl_add_u32 v160, v1, 4, s7
    v_add_u32 v161, 8192, v160
    s_lshl_b32 s7, s35, 1
    s_movk_i32 s9, 896
    v_lshl_add_u32 v162, v3, 4, s7
    v_add_u32 v163, s34, v2
    v_mad_u32_u24 v163, v163, s9, v162
    global_load_dwordx4 v[184:187], v163, s[16:17]
    global_load_dwordx4 v[188:191], v162, s[32:33]
    global_load_dwordx4 v[192:195], v162, s[50:51]
    s_bitcmp1_b32 s3, 0
    s_cbranch_scc1 LCB1
    s_waitcnt lgkmcnt(0)
    v_mfma_f32_16x16x32_bf16 v[136:139], v[72:75], v[132:135], v[136:139]
    ds_read2_b32 v[8:9], v4 offset0:144 offset1:145
    ds_read2_b32 v[10:11], v4 offset0:146 offset1:147
    v_mfma_f32_16x16x32_bf16 v[140:143], v[72:75], v[128:131], v[140:143]
    s_add_u32 m0, s14, 0
    s_nop 0
    global_load_lds_dwordx4 v253, s[44:45] offset:0
    ds_read_b128 v[40:43], v152 offset:64
    ds_read2_b32 v[12:13], v4 offset0:16 offset1:17
    v_mfma_f32_16x16x32_bf16 v[144:147], v[72:75], v[108:111], v[144:147]
    ds_read2_b32 v[14:15], v4 offset0:18 offset1:19
    ds_read_b128 v[44:47], v152 offset:576
    v_mfma_f32_16x16x32_bf16 v[148:151], v[72:75], v[104:107], v[148:151]
    s_add_u32 m0, s14, 896
    s_nop 0
    global_load_lds_dwordx4 v253, s[44:45] offset:128
    ds_read2_b32 v[16:17], v5 offset0:144 offset1:145
    ds_read2_b32 v[18:19], v5 offset0:146 offset1:147
    v_mfma_f32_16x16x32_bf16 v[136:139], v[76:79], v[128:131], v[136:139]
    ds_read_b128 v[48:51], v152 offset:1088
    ds_read2_b32 v[20:21], v5 offset0:16 offset1:17
    v_mfma_f32_16x16x32_bf16 v[140:143], v[76:79], v[124:127], v[140:143]
    s_add_u32 m0, s14, 1792
    s_nop 0
    global_load_lds_dwordx4 v253, s[44:45] offset:256
    ds_read2_b32 v[22:23], v5 offset0:18 offset1:19
    ds_read_b128 v[52:55], v152 offset:1600
    v_mfma_f32_16x16x32_bf16 v[144:147], v[76:79], v[104:107], v[144:147]
    ds_read2_b32 v[24:25], v6 offset0:144 offset1:145
    ds_read2_b32 v[26:27], v6 offset0:146 offset1:147
    v_mfma_f32_16x16x32_bf16 v[136:139], v[80:83], v[124:127], v[136:139]
    s_add_u32 m0, s14, 2688
    s_nop 0
    global_load_lds_dwordx4 v253, s[44:45] offset:384
    ds_read_b128 v[56:59], v152 offset:2112
    ds_read2_b32 v[28:29], v6 offset0:16 offset1:17
    v_mfma_f32_16x16x32_bf16 v[140:143], v[80:83], v[120:123], v[140:143]
    ds_read2_b32 v[30:31], v6 offset0:18 offset1:19
    ds_read_b128 v[60:63], v152 offset:2624
    v_mfma_f32_16x16x32_bf16 v[136:139], v[84:87], v[120:123], v[136:139]
    s_add_u32 m0, s14, 3584
    s_nop 0
    global_load_lds_dwordx4 v253, s[44:45] offset:512
    ds_read2_b32 v[32:33], v7 offset0:144 offset1:145
    ds_read2_b32 v[34:35], v7 offset0:146 offset1:147
    v_mfma_f32_16x16x32_bf16 v[140:143], v[84:87], v[116:119], v[140:143]
    ds_read_b128 v[64:67], v152 offset:3136
    ds_read2_b32 v[36:37], v7 offset0:16 offset1:17
    v_mfma_f32_16x16x32_bf16 v[136:139], v[88:91], v[116:119], v[136:139]
    s_add_u32 m0, s14, 4480
    s_nop 0
    global_load_lds_dwordx4 v253, s[44:45] offset:640
    ds_read2_b32 v[38:39], v7 offset0:18 offset1:19
    ds_read_b128 v[68:71], v152 offset:3648
    v_mfma_f32_16x16x32_bf16 v[140:143], v[88:91], v[112:115], v[140:143]
    v_mfma_f32_16x16x32_bf16 v[136:139], v[92:95], v[112:115], v[136:139]
    s_add_u32 m0, s14, 5376
    s_nop 0
    global_load_lds_dwordx4 v253, s[44:45] offset:768
    v_mfma_f32_16x16x32_bf16 v[140:143], v[92:95], v[108:111], v[140:143]
    v_mfma_f32_16x16x32_bf16 v[136:139], v[96:99], v[108:111], v[136:139]
    v_mfma_f32_16x16x32_bf16 v[140:143], v[96:99], v[104:107], v[140:143]
    v_mfma_f32_16x16x32_bf16 v[136:139], v[100:103], v[104:107], v[136:139]
    s_nop 7
    s_branch LCE1
LCB1:
    s_waitcnt lgkmcnt(0)
    v_mfma_f32_16x16x32_bf16 v[136:139], v[72:75], v[124:127], v[136:139]
    ds_read2_b32 v[8:9], v4 offset0:144 offset1:145
    ds_read2_b32 v[10:11], v4 offset0:146 offset1:147
    v_mfma_f32_16x16x32_bf16 v[140:143], v[72:75], v[120:123], v[140:143]
    s_add_u32 m0, s14, 0
    s_nop 0
    global_load_lds_dwordx4 v253, s[44:45] offset:0
    ds_read_b128 v[40:43], v152 offset:64
    ds_read2_b32 v[12:13], v4 offset0:16 offset1:17
    v_mfma_f32_16x16x32_bf16 v[144:147], v[72:75], v[116:119], v[144:147]
    ds_read2_b32 v[14:15], v4 offset0:18 offset1:19
    ds_read_b128 v[44:47], v152 offset:576
    v_mfma_f32_16x16x32_bf16 v[148:151], v[72:75], v[112:115], v[148:151]
    s_add_u32 m0, s14, 896
    s_nop 0
    global_load_lds_dwordx4 v253, s[44:45] offset:128
    ds_read2_b32 v[16:17], v5 offset0:144 offset1:145
    ds_read2_b32 v[18:19], v5 offset0:146 offset1:147
    v_mfma_f32_16x16x32_bf16 v[136:139], v[76:79], v[120:123], v[136:139]
    ds_read_b128 v[48:51], v152 offset:1088
    ds_read2_b32 v[20:21], v5 offset0:16 offset1:17
    v_mfma_f32_16x16x32_bf16 v[140:143], v[76:79], v[116:119], v[140:143]
    s_add_u32 m0, s14, 1792
    s_nop 0
    global_load_lds_dwordx4 v253, s[44:45] offset:256
    ds_read2_b32 v[22:23], v5 offset0:18 offset1:19
    ds_read_b128 v[52:55], v152 offset:1600
    v_mfma_f32_16x16x32_bf16 v[144:147], v[76:79], v[112:115], v[144:147]
    ds_read2_b32 v[24:25], v6 offset0:144 offset1:145
    ds_read2_b32 v[26:27], v6 offset0:146 offset1:147
    v_mfma_f32_16x16x32_bf16 v[148:151], v[76:79], v[108:111], v[148:151]
    s_add_u32 m0, s14, 2688
    s_nop 0
    global_load_lds_dwordx4 v253, s[44:45] offset:384
    ds_read_b128 v[56:59], v152 offset:2112
    ds_read2_b32 v[28:29], v6 offset0:16 offset1:17
    v_mfma_f32_16x16x32_bf16 v[136:139], v[80:83], v[116:119], v[136:139]
    ds_read2_b32 v[30:31], v6 offset0:18 offset1:19
    ds_read_b128 v[60:63], v152 offset:2624
    v_mfma_f32_16x16x32_bf16 v[140:143], v[80:83], v[112:115], v[140:143]
    s_add_u32 m0, s14, 3584
    s_nop 0
    global_load_lds_dwordx4 v253, s[44:45] offset:512
    v_mfma_f32_16x16x32_bf16 v[144:147], v[80:83], v[108:111], v[144:147]
    v_mfma_f32_16x16x32_bf16 v[148:151], v[80:83], v[104:107], v[148:151]
    s_add_u32 m0, s14, 4480
    s_nop 0
    global_load_lds_dwordx4 v253, s[44:45] offset:640
    v_mfma_f32_16x16x32_bf16 v[136:139], v[84:87], v[112:115], v[136:139]
    v_mfma_f32_16x16x32_bf16 v[140:143], v[84:87], v[108:111], v[140:143]
    s_add_u32 m0, s14, 5376
    s_nop 0
    global_load_lds_dwordx4 v253, s[44:45] offset:768
    v_mfma_f32_16x16x32_bf16 v[144:147], v[84:87], v[104:107], v[144:147]
    v_mfma_f32_16x16x32_bf16 v[136:139], v[88:91], v[108:111], v[136:139]
    v_mfma_f32_16x16x32_bf16 v[140:143], v[88:91], v[104:107], v[140:143]
    v_mfma_f32_16x16x32_bf16 v[136:139], v[92:95], v[104:107], v[136:139]
    s_nop 7
LCE1:
    s_bitcmp1_b32 s3, 0
    s_cbranch_scc1 LCB2
    s_waitcnt lgkmcnt(0)
    v_mfma_f32_16x16x32_bf16 v[136:139], v[8:11], v[68:71], v[136:139]
    ds_read2_b32 v[72:73], v4 offset0:128 offset1:129
    ds_read2_b32 v[74:75], v4 offset0:130 offset1:131
    v_mfma_f32_16x16x32_bf16 v[140:143], v[8:11], v[64:67], v[140:143]
    s_add_u32 m0, s14, 57344
    s_nop 0
    global_load_lds_dwordx4 v253, s[46:47] offset:0
    ds_read_b128 v[104:107], v152 offset:0
    ds_read2_b32 v[76:77], v4 offset0:0 offset1:1
    v_mfma_f32_16x16x32_bf16 v[144:147], v[8:11], v[44:47], v[144:147]
    ds_read2_b32 v[78:79], v4 offset0:2 offset1:3
    ds_read_b128 v[108:111], v152 offset:512
    v_mfma_f32_16x16x32_bf16 v[148:151], v[8:11], v[40:43], v[148:151]
    s_add_u32 m0, s14, 58240
    s_nop 0
    global_load_lds_dwordx4 v253, s[46:47] offset:128
    ds_read2_b32 v[80:81], v5 offset0:128 offset1:129
    ds_read2_b32 v[82:83], v5 offset0:130 offset1:131
    v_mfma_f32_16x16x32_bf16 v[136:139], v[12:15], v[64:67], v[136:139]
    ds_read_b128 v[112:115], v152 offset:1024
    ds_read2_b32 v[84:85], v5 offset0:0 offset1:1
    v_mfma_f32_16x16x32_bf16 v[140:143], v[12:15], v[60:63], v[140:143]
    s_add_u32 m0, s14, 59136
    s_nop 0
    global_load_lds_dwordx4 v253, s[46:47] offset:256
    ds_read2_b32 v[86:87], v5 offset0:2 offset1:3
    ds_read_b128 v[116:119], v152 offset:1536
    v_mfma_f32_16x16x32_bf16 v[144:147], v[12:15], v[40:43], v[144:147]
    ds_read2_b32 v[88:89], v6 offset0:128 offset1:129
    ds_read2_b32 v[90:91], v6 offset0:130 offset1:131
    v_mfma_f32_16x16x32_bf16 v[136:139], v[16:19], v[60:63], v[136:139]
    s_add_u32 m0, s14, 60032
    s_nop 0
    global_load_lds_dwordx4 v253, s[46:47] offset:384
    ds_read_b128 v[120:123], v152 offset:2048
    ds_read2_b32 v[92:93], v6 offset0:0 offset1:1
    v_mfma_f32_16x16x32_bf16 v[140:143], v[16:19], v[56:59], v[140:143]
    ds_read2_b32 v[94:95], v6 offset0:2 offset1:3
    ds_read_b128 v[124:127], v152 offset:2560
    v_mfma_f32_16x16x32_bf16 v[136:139], v[20:23], v[56:59], v[136:139]
    s_add_u32 m0, s14, 60928
    s_nop 0
    global_load_lds_dwordx4 v253, s[46:47] offset:512
    ds_read2_b32 v[96:97], v7 offset0:128 offset1:129
    ds_read2_b32 v[98:99], v7 offset0:130 offset1:131
    v_mfma_f32_16x16x32_bf16 v[140:143], v[20:23], v[52:55], v[140:143]
    ds_read_b128 v[128:131], v152 offset:3072
    ds_read2_b32 v[100:101], v7 offset0:0 offset1:1
    v_mfma_f32_16x16x32_bf16 v[136:139], v[24:27], v[52:55], v[136:139]
    s_add_u32 m0, s14, 61824
    s_nop 0
    global_load_lds_dwordx4 v253, s[46:47] offset:640
    ds_read2_b32 v[102:103], v7 offset0:2 offset1:3
    ds_read_b128 v[132:135], v152 offset:3584
    v_mfma_f32_16x16x32_bf16 v[140:143], v[24:27], v[48:51], v[140:143]
    v_mfma_f32_16x16x32_bf16 v[136:139], v[28:31], v[48:51], v[136:139]
    s_add_u32 m0, s14, 62720
    s_nop 0
    global_load_lds_dwordx4 v253, s[46:47] offset:768
    v_mfma_f32_16x16x32_bf16 v[140:143], v[28:31], v[44:47], v[140:143]
    v_mfma_f32_16x16x32_bf16 v[136:139], v[32:35], v[44:47], v[136:139]
    v_mfma_f32_16x16x32_bf16 v[140:143], v[32:35], v[40:43], v[140:143]
    v_mfma_f32_16x16x32_bf16 v[136:139], v[36:39], v[40:43], v[136:139]
    s_nop 7
    s_branch LCE2
LCB2:
    s_waitcnt lgkmcnt(0)
    v_mfma_f32_16x16x32_bf16 v[136:139], v[8:11], v[60:63], v[136:139]
    ds_read2_b32 v[72:73], v4 offset0:128 offset1:129
    ds_read2_b32 v[74:75], v4 offset0:130 offset1:131
    v_mfma_f32_16x16x32_bf16 v[140:143], v[8:11], v[56:59], v[140:143]
    s_add_u32 m0, s14, 57344
    s_nop 0
    global_load_lds_dwordx4 v253, s[46:47] offset:0
    ds_read_b128 v[104:107], v152 offset:0
    ds_read2_b32 v[76:77], v4 offset0:0 offset1:1
    v_mfma_f32_16x16x32_bf16 v[144:147], v[8:11], v[52:55], v[144:147]
    ds_read2_b32 v[78:79], v4 offset0:2 offset1:3
    ds_read_b128 v[108:111], v152 offset:512
    v_mfma_f32_16x16x32_bf16 v[148:151], v[8:11], v[48:51], v[148:151]
    s_add_u32 m0, s14, 58240
    s_nop 0
    global_load_lds_dwordx4 v253, s[46:47] offset:128
    ds_read2_b32 v[80:81], v5 offset0:128 offset1:129
    ds_read2_b32 v[82:83], v5 offset0:130 offset1:131
    v_mfma_f32_16x16x32_bf16 v[136:139], v[12:15], v[56:59], v[136:139]
    ds_read_b128 v[112:115], v152 offset:1024
    ds_read2_b32 v[84:85], v5 offset0:0 offset1:1
    v_mfma_f32_16x16x32_bf16 v[140:143], v[12:15], v[52:55], v[140:143]
    s_add_u32 m0, s14, 59136
    s_nop 0
    global_load_lds_dwordx4 v253, s[46:47] offset:256
    ds_read2_b32 v[86:87], v5 offset0:2 offset1:3
    ds_read_b128 v[116:119], v152 offset:1536
    v_mfma_f32_16x16x32_bf16 v[144:147], v[12:15], v[48:51], v[144:147]
    ds_read2_b32 v[88:89], v6 offset0:128 offset1:129
    ds_read2_b32 v[90:91], v6 offset0:130 offset1:131
    v_mfma_f32_16x16x32_bf16 v[148:151], v[12:15], v[44:47], v[148:151]
    s_add_u32 m0, s14, 60032
    s_nop 0
    global_load_lds_dwordx4 v253, s[46:47] offset:384
    ds_read_b128 v[120:123], v152 offset:2048
    ds_read2_b32 v[92:93], v6 offset0:0 offset1:1
    v_mfma_f32_16x16x32_bf16 v[136:139], v[16:19], v[52:55], v[136:139]
    ds_read2_b32 v[94:95], v6 offset0:2 offset1:3
    ds_read_b128 v[124:127], v152 offset:2560
    v_mfma_f32_16x16x32_bf16 v[140:143], v[16:19], v[48:51], v[140:143]
    s_add_u32 m0, s14, 60928
    s_nop 0
    global_load_lds_dwordx4 v253, s[46:47] offset:512
    v_mfma_f32_16x16x32_bf16 v[144:147], v[16:19], v[44:47], v[144:147]
    v_mfma_f32_16x16x32_bf16 v[148:151], v[16:19], v[40:43], v[148:151]
    s_add_u32 m0, s14, 61824
    s_nop 0
    global_load_lds_dwordx4 v253, s[46:47] offset:640
    v_mfma_f32_16x16x32_bf16 v[136:139], v[20:23], v[48:51], v[136:139]
    v_mfma_f32_16x16x32_bf16 v[140:143], v[20:23], v[44:47], v[140:143]
    s_add_u32 m0, s14, 62720
    s_nop 0
    global_load_lds_dwordx4 v253, s[46:47] offset:768
    v_mfma_f32_16x16x32_bf16 v[144:147], v[20:23], v[40:43], v[144:147]
    v_mfma_f32_16x16x32_bf16 v[136:139], v[24:27], v[44:47], v[136:139]
    v_mfma_f32_16x16x32_bf16 v[140:143], v[24:27], v[40:43], v[140:143]
    v_mfma_f32_16x16x32_bf16 v[136:139], v[28:31], v[40:43], v[136:139]
    s_nop 7
LCE2:
    s_bitcmp1_b32 s3, 0
    s_cbranch_scc1 LCB3
    s_waitcnt lgkmcnt(0)
    v_mfma_f32_16x16x32_bf16 v[136:139], v[72:75], v[132:135], v[136:139]
    v_mfma_f32_16x16x32_bf16 v[140:143], v[72:75], v[128:131], v[140:143]
    s_lshr_b32 s7, s3, 1
    s_mul_i32 s7, s7, 1280
    s_add_u32 s7, s7, 114688
    v_mfma_f32_16x16x32_bf16 v[144:147], v[72:75], v[108:111], v[144:147]
    v_mfma_f32_16x16x32_bf16 v[148:151], v[72:75], v[104:107], v[148:151]
    v_mul_u32_u24 v164, 320, v3
    v_lshl_add_u32 v164, v2, 4, v164
    v_add_u32 v164, s7, v164
    v_mfma_f32_16x16x32_bf16 v[136:139], v[76:79], v[128:131], v[136:139]
    v_mfma_f32_16x16x32_bf16 v[140:143], v[76:79], v[124:127], v[140:143]
    s_mul_i32 s32, s3, 5120
    s_add_u32 s32, s32, 114688
    v_lshrrev_b32 v165, 3, v1
    v_mfma_f32_16x16x32_bf16 v[144:147], v[76:79], v[104:107], v[144:147]
    v_mfma_f32_16x16x32_bf16 v[136:139], v[80:83], v[124:127], v[136:139]
    v_lshlrev_b32 v165, 4, v165
    v_bfe_u32 v166, v1, 1, 2
    v_mul_u32_u24 v166, 320, v166
    v_mfma_f32_16x16x32_bf16 v[140:143], v[80:83], v[120:123], v[140:143]
    v_mfma_f32_16x16x32_bf16 v[136:139], v[84:87], v[120:123], v[136:139]
    v_and_b32 v167, 1, v1
    v_lshl_add_u32 v165, v167, 3, v165
    v_add3_u32 v165, v165, v166, s32
    v_mfma_f32_16x16x32_bf16 v[140:143], v[84:87], v[116:119], v[140:143]
    v_mfma_f32_16x16x32_bf16 v[136:139], v[88:91], v[116:119], v[136:139]
    s_lshl_b32 s7, s4, 14
    s_lshl_b32 s61, s3, 11
    s_add_u32 s7, s7, s61
    v_mfma_f32_16x16x32_bf16 v[140:143], v[88:91], v[112:115], v[140:143]
    v_mfma_f32_16x16x32_bf16 v[136:139], v[92:95], v[112:115], v[136:139]
    s_add_u32 s7, s7, 4194304
    v_lshl_add_u32 v166, v1, 4, s7
    s_mul_i32 s7, s101, 57344
    v_mfma_f32_16x16x32_bf16 v[140:143], v[92:95], v[108:111], v[140:143]
    v_mfma_f32_16x16x32_bf16 v[136:139], v[96:99], v[108:111], v[136:139]
    v_add_u32 v153, s7, v153
    v_mfma_f32_16x16x32_bf16 v[140:143], v[96:99], v[104:107], v[140:143]
    v_mfma_f32_16x16x32_bf16 v[136:139], v[100:103], v[104:107], v[136:139]
    s_nop 7
    s_branch LCE3
LCB3:
    s_waitcnt lgkmcnt(0)
    v_mfma_f32_16x16x32_bf16 v[136:139], v[72:75], v[124:127], v[136:139]
    v_mfma_f32_16x16x32_bf16 v[140:143], v[72:75], v[120:123], v[140:143]
    s_lshr_b32 s7, s3, 1
    s_mul_i32 s7, s7, 1280
    s_add_u32 s7, s7, 114688
    v_mfma_f32_16x16x32_bf16 v[144:147], v[72:75], v[116:119], v[144:147]
    v_mfma_f32_16x16x32_bf16 v[148:151], v[72:75], v[112:115], v[148:151]
    v_mul_u32_u24 v164, 320, v3
    v_lshl_add_u32 v164, v2, 4, v164
    v_add_u32 v164, s7, v164
    v_mfma_f32_16x16x32_bf16 v[136:139], v[76:79], v[120:123], v[136:139]
    v_mfma_f32_16x16x32_bf16 v[140:143], v[76:79], v[116:119], v[140:143]
    s_mul_i32 s32, s3, 5120
    s_add_u32 s32, s32, 114688
    v_lshrrev_b32 v165, 3, v1
    v_mfma_f32_16x16x32_bf16 v[144:147], v[76:79], v[112:115], v[144:147]
    v_mfma_f32_16x16x32_bf16 v[148:151], v[76:79], v[108:111], v[148:151]
    v_lshlrev_b32 v165, 4, v165
    v_bfe_u32 v166, v1, 1, 2
    v_mul_u32_u24 v166, 320, v166
    v_mfma_f32_16x16x32_bf16 v[136:139], v[80:83], v[116:119], v[136:139]
    v_mfma_f32_16x16x32_bf16 v[140:143], v[80:83], v[112:115], v[140:143]
    v_and_b32 v167, 1, v1
    v_lshl_add_u32 v165, v167, 3, v165
    v_add3_u32 v165, v165, v166, s32
    v_mfma_f32_16x16x32_bf16 v[144:147], v[80:83], v[108:111], v[144:147]
    v_mfma_f32_16x16x32_bf16 v[148:151], v[80:83], v[104:107], v[148:151]
    s_lshl_b32 s7, s4, 14
    s_lshl_b32 s61, s3, 11
    s_add_u32 s7, s7, s61
    v_mfma_f32_16x16x32_bf16 v[136:139], v[84:87], v[112:115], v[136:139]
    v_mfma_f32_16x16x32_bf16 v[140:143], v[84:87], v[108:111], v[140:143]
    s_add_u32 s7, s7, 4194304
    v_lshl_add_u32 v166, v1, 4, s7
    s_mul_i32 s7, s101, 57344
    v_mfma_f32_16x16x32_bf16 v[144:147], v[84:87], v[104:107], v[144:147]
    v_mfma_f32_16x16x32_bf16 v[136:139], v[88:91], v[108:111], v[136:139]
    v_add_u32 v153, s7, v153
    v_mfma_f32_16x16x32_bf16 v[140:143], v[88:91], v[104:107], v[140:143]
    v_mfma_f32_16x16x32_bf16 v[136:139], v[92:95], v[104:107], v[136:139]
    s_nop 7
LCE3:
    s_barrier
    s_bitcmp1_b32 s3, 0
    s_cbranch_scc1 LPW1
    ds_write_b128 v164, v[136:139] offset:35840
    ds_write_b128 v164, v[140:143] offset:30720
    ds_write_b128 v164, v[144:147] offset:5120
    ds_write_b128 v164, v[148:151] offset:0
    s_branch LPW2
LPW1:
    ds_write_b128 v164, v[136:139] offset:25600
    ds_write_b128 v164, v[140:143] offset:20480
    ds_write_b128 v164, v[144:147] offset:15360
    ds_write_b128 v164, v[148:151] offset:10240
LPW2:
    v_xor_b32 v152, 64, v153
    s_waitcnt vmcnt(0) lgkmcnt(0)
    global_load_dword v157, v156, s[58:59] sc1
    s_barrier
    ds_read_b64 v[8:9], v165 offset:0
    ds_read_b64 v[10:11], v165 offset:1280
    ds_read_b64 v[12:13], v165 offset:2560
    ds_read_b64 v[14:15], v165 offset:3840
    ds_read_b64 v[16:17], v165 offset:128
    ds_read_b64 v[18:19], v165 offset:1408
    ds_read_b64 v[20:21], v165 offset:2688
    ds_read_b64 v[22:23], v165 offset:3968
    v_mov_b32 v25, s31
    v_mov_b32 v27, s31
    v_mov_b32 v29, s31
    v_mov_b32 v31, s31
    s_waitcnt lgkmcnt(0)
    v_pk_add_f32 v[8:9], v[8:9], v[10:11]
    v_pk_add_f32 v[12:13], v[12:13], v[14:15]
    v_cvt_pk_bf16_f32 v24, v8, v12
    v_cvt_pk_bf16_f32 v26, v9, v13
    global_store_dwordx4 v166, v[24:27], s[58:59] offset:0 sc1
    v_pk_add_f32 v[16:17], v[16:17], v[18:19]
    v_pk_add_f32 v[20:21], v[20:21], v[22:23]
    v_cvt_pk_bf16_f32 v28, v16, v20
    v_cvt_pk_bf16_f32 v30, v17, v21
    global_store_dwordx4 v166, v[28:31], s[58:59] offset:1024 sc1
    s_mov_b32 s7, 0
    s_waitcnt vmcnt(2)
LTG2:
    v_xor_b32 v158, s31, v157
    v_cmp_ne_u32 vcc, 0, v158
    s_nop 4
    s_cbranch_vccz LTD2
    s_add_u32 s7, s7, 1
    s_cmp_gt_u32 s7, 0x40000
    s_cbranch_scc1 LTD2
    s_sleep 2
    global_load_dword v157, v156, s[58:59] sc1
    s_waitcnt vmcnt(0)
    s_branch LTG2
LTD2:
    global_load_dwordx4 v[200:203], v160, s[58:59] offset:-4096 sc1
    global_load_dwordx4 v[204:207], v160, s[58:59] offset:-3072 sc1
    global_load_dwordx4 v[208:211], v160, s[58:59] offset:-2048 sc1
    global_load_dwordx4 v[212:215], v160, s[58:59] offset:-1024 sc1
    global_load_dwordx4 v[216:219], v160, s[58:59] offset:0 sc1
    ds_read_b128 v[32:35], v152 offset:0
    ds_read_b128 v[36:39], v152 offset:14336
    ds_read_b128 v[40:43], v152 offset:28672
    ds_read_b128 v[44:47], v152 offset:43008
    ds_read_b128 v[48:51], v153 offset:0
    ds_read_b128 v[52:55], v153 offset:14336
    ds_read_b128 v[56:59], v153 offset:28672
    ds_read_b128 v[60:63], v153 offset:43008
    ds_read_b128 v[64:67], v152 offset:1024
    ds_read_b128 v[68:71], v152 offset:15360
    ds_read_b128 v[72:75], v152 offset:29696
    ds_read_b128 v[76:79], v152 offset:44032
    ds_read_b128 v[80:83], v153 offset:1024
    ds_read_b128 v[84:87], v153 offset:15360
    ds_read_b128 v[88:91], v153 offset:29696
    ds_read_b128 v[92:95], v153 offset:44032
    ds_read_b128 v[140:143], v152 offset:2048
    ds_read_b128 v[144:147], v152 offset:16384
    ds_read_b128 v[148:151], v152 offset:30720
    ds_read_b128 v[164:167], v152 offset:45056
    v_lshlrev_b32 v96, 16, v184
    v_and_b32 v97, 0xffff0000, v184
    v_lshlrev_b32 v104, 16, v188
    v_and_b32 v105, 0xffff0000, v188
    v_lshlrev_b32 v112, 16, v192
    v_and_b32 v113, 0xffff0000, v192
    v_lshlrev_b32 v98, 16, v185
    v_and_b32 v99, 0xffff0000, v185
    v_lshlrev_b32 v106, 16, v189
    v_and_b32 v107, 0xffff0000, v189
    v_lshlrev_b32 v114, 16, v193
    v_and_b32 v115, 0xffff0000, v193
    v_lshlrev_b32 v100, 16, v186
    v_and_b32 v101, 0xffff0000, v186
    v_lshlrev_b32 v108, 16, v190
    v_and_b32 v109, 0xffff0000, v190
    v_lshlrev_b32 v116, 16, v194
    v_and_b32 v117, 0xffff0000, v194
    global_load_dwordx4 v[220:223], v160, s[58:59] offset:1024 sc1
    v_lshlrev_b32 v102, 16, v187
    v_and_b32 v103, 0xffff0000, v187
    v_lshlrev_b32 v110, 16, v191
    v_and_b32 v111, 0xffff0000, v191
    v_lshlrev_b32 v118, 16, v195
    v_and_b32 v119, 0xffff0000, v195
    v_pk_mul_f32 v[104:105], v[104:105], v[96:97]
    v_pk_mul_f32 v[112:113], v[112:113], v[96:97]
    v_cvt_pk_bf16_f32 v104, v104, v105
    v_cvt_pk_bf16_f32 v112, v112, v113
    v_lshlrev_b32 v184, 16, v104
    v_and_b32 v185, 0xffff0000, v104
    v_lshlrev_b32 v192, 16, v112
    v_and_b32 v193, 0xffff0000, v112
    v_pk_mul_f32 v[106:107], v[106:107], v[98:99]
    v_pk_mul_f32 v[114:115], v[114:115], v[98:99]
    v_cvt_pk_bf16_f32 v106, v106, v107
    v_cvt_pk_bf16_f32 v114, v114, v115
    global_load_dwordx4 v[224:227], v160, s[58:59] offset:2048 sc1
    v_lshlrev_b32 v186, 16, v106
    v_and_b32 v187, 0xffff0000, v106
    v_lshlrev_b32 v194, 16, v114
    v_and_b32 v195, 0xffff0000, v114
    v_pk_mul_f32 v[108:109], v[108:109], v[100:101]
    v_pk_mul_f32 v[116:117], v[116:117], v[100:101]
    v_cvt_pk_bf16_f32 v108, v108, v109
    v_cvt_pk_bf16_f32 v116, v116, v117
    v_lshlrev_b32 v188, 16, v108
    v_and_b32 v189, 0xffff0000, v108
    v_lshlrev_b32 v196, 16, v116
    v_and_b32 v197, 0xffff0000, v116
    v_pk_mul_f32 v[110:111], v[110:111], v[102:103]
    v_pk_mul_f32 v[118:119], v[118:119], v[102:103]
    v_cvt_pk_bf16_f32 v110, v110, v111
    v_cvt_pk_bf16_f32 v118, v118, v119
    v_lshlrev_b32 v190, 16, v110
    v_and_b32 v191, 0xffff0000, v110
    global_load_dwordx4 v[228:231], v160, s[58:59] offset:3072 sc1
    v_lshlrev_b32 v198, 16, v118
    v_and_b32 v199, 0xffff0000, v118
    s_lshr_b32 s7, s35, 1
    s_lshl_b32 s7, s7, 14
    s_add_u32 s7, s7, 4194304
    v_add_u32 v8, s34, v2
    v_lshlrev_b32 v6, 3, v8
    v_add_u32 v7, 12582912, v6
    v_lshl_add_u32 v6, v3, 16, v6
    v_add_u32 v6, s7, v6
    v_add_u32 v10, 16384, v6
    v_add_u32 v11, 32768, v6
    v_add_u32 v12, 49152, v6
    v_lshl_add_u32 v5, v1, 4, s32
    s_xor_b32 s7, s3, 4
    s_mul_i32 s7, s7, 5120
    s_add_u32 s7, s7, 114688
    v_lshl_add_u32 v4, v1, 4, s7
    v_mul_u32_u24 v96, 144, v2
    v_lshl_add_u32 v96, v3, 5, v96
    v_add_u32 v96, s32, v96
    v_lshrrev_b32 v97, 3, v1
    v_and_b32 v99, 7, v1
    v_mul_u32_u24 v100, 144, v97
    v_lshl_add_u32 v100, v99, 4, v100
    v_add_u32 v100, s32, v100
    v_add_u32 v98, s34, v97
    v_mul_u32_u24 v98, 1792, v98
    v_lshl_add_u32 v98, v99, 4, v98
    s_lshl_b32 s7, s35, 2
    v_add_u32 v98, s7, v98
    v_add_u32 v99, 14336, v98
    s_waitcnt vmcnt(7) lgkmcnt(15)
    global_load_dwordx4 v[232:235], v161, s[58:59] offset:-4096 sc1
    v_mfma_f32_16x16x32_bf16 v[124:127], v[32:35], v[200:203], 0
    ds_read_b128 v[168:171], v153 offset:2048
    v_mfma_f32_16x16x32_bf16 v[128:131], v[36:39], v[200:203], 0
    ds_read_b128 v[172:175], v153 offset:16384
    v_mfma_f32_16x16x32_bf16 v[132:135], v[40:43], v[200:203], 0
    ds_read_b128 v[176:179], v153 offset:30720
    v_mfma_f32_16x16x32_bf16 v[136:139], v[44:47], v[200:203], 0
    ds_read_b128 v[180:183], v153 offset:45056
    s_waitcnt vmcnt(7) lgkmcnt(15)
    global_load_dwordx4 v[236:239], v161, s[58:59] offset:-3072 sc1
    v_mfma_f32_16x16x32_bf16 v[124:127], v[48:51], v[204:207], v[124:127]
    ds_read_b128 v[32:35], v152 offset:3072
    v_mfma_f32_16x16x32_bf16 v[128:131], v[52:55], v[204:207], v[128:131]
    ds_read_b128 v[36:39], v152 offset:17408
    v_mfma_f32_16x16x32_bf16 v[132:135], v[56:59], v[204:207], v[132:135]
    ds_read_b128 v[40:43], v152 offset:31744
    v_mfma_f32_16x16x32_bf16 v[136:139], v[60:63], v[204:207], v[136:139]
    ds_read_b128 v[44:47], v152 offset:46080
    s_waitcnt vmcnt(7) lgkmcnt(15)
    global_load_dwordx4 v[240:243], v161, s[58:59] offset:-2048 sc1
    v_mfma_f32_16x16x32_bf16 v[124:127], v[64:67], v[208:211], v[124:127]
    ds_read_b128 v[48:51], v153 offset:3072
    v_mfma_f32_16x16x32_bf16 v[128:131], v[68:71], v[208:211], v[128:131]
    ds_read_b128 v[52:55], v153 offset:17408
    v_mfma_f32_16x16x32_bf16 v[132:135], v[72:75], v[208:211], v[132:135]
    ds_read_b128 v[56:59], v153 offset:31744
    v_mfma_f32_16x16x32_bf16 v[136:139], v[76:79], v[208:211], v[136:139]
    ds_read_b128 v[60:63], v153 offset:46080
    s_waitcnt vmcnt(7) lgkmcnt(15)
    global_load_dwordx4 v[244:247], v161, s[58:59] offset:-1024 sc1
    v_mfma_f32_16x16x32_bf16 v[124:127], v[80:83], v[212:215], v[124:127]
    ds_read_b128 v[64:67], v152 offset:4096
    v_mfma_f32_16x16x32_bf16 v[128:131], v[84:87], v[212:215], v[128:131]
    ds_read_b128 v[68:71], v152 offset:18432
    v_mfma_f32_16x16x32_bf16 v[132:135], v[88:91], v[212:215], v[132:135]
    ds_read_b128 v[72:75], v152 offset:32768
    v_mfma_f32_16x16x32_bf16 v[136:139], v[92:95], v[212:215], v[136:139]
    ds_read_b128 v[76:79], v152 offset:47104
    s_waitcnt vmcnt(7) lgkmcnt(15)
    global_load_dwordx4 v[248:251], v161, s[58:59] offset:0 sc1
    v_mfma_f32_16x16x32_bf16 v[124:127], v[140:143], v[216:219], v[124:127]
    ds_read_b128 v[80:83], v153 offset:4096
    v_mfma_f32_16x16x32_bf16 v[128:131], v[144:147], v[216:219], v[128:131]
    ds_read_b128 v[84:87], v153 offset:18432
    v_mfma_f32_16x16x32_bf16 v[132:135], v[148:151], v[216:219], v[132:135]
    ds_read_b128 v[88:91], v153 offset:32768
    v_mfma_f32_16x16x32_bf16 v[136:139], v[164:167], v[216:219], v[136:139]
    ds_read_b128 v[92:95], v153 offset:47104
    s_waitcnt vmcnt(7) lgkmcnt(15)
    global_load_dwordx4 v[252:255], v161, s[58:59] offset:1024 sc1
    v_mfma_f32_16x16x32_bf16 v[124:127], v[168:171], v[220:223], v[124:127]
    ds_read_b128 v[140:143], v152 offset:5120
    v_mfma_f32_16x16x32_bf16 v[128:131], v[172:175], v[220:223], v[128:131]
    ds_read_b128 v[144:147], v152 offset:19456
    v_mfma_f32_16x16x32_bf16 v[132:135], v[176:179], v[220:223], v[132:135]
    ds_read_b128 v[148:151], v152 offset:33792
    v_mfma_f32_16x16x32_bf16 v[136:139], v[180:183], v[220:223], v[136:139]
    ds_read_b128 v[164:167], v152 offset:48128
    s_waitcnt vmcnt(7) lgkmcnt(15)
    v_mfma_f32_16x16x32_bf16 v[124:127], v[32:35], v[224:227], v[124:127]
    ds_read_b128 v[168:171], v153 offset:5120
    v_mfma_f32_16x16x32_bf16 v[128:131], v[36:39], v[224:227], v[128:131]
    ds_read_b128 v[172:175], v153 offset:19456
    v_mfma_f32_16x16x32_bf16 v[132:135], v[40:43], v[224:227], v[132:135]
    ds_read_b128 v[176:179], v153 offset:33792
    v_mfma_f32_16x16x32_bf16 v[136:139], v[44:47], v[224:227], v[136:139]
    ds_read_b128 v[180:183], v153 offset:48128
    s_waitcnt vmcnt(6) lgkmcnt(15)
    v_mfma_f32_16x16x32_bf16 v[124:127], v[48:51], v[228:231], v[124:127]
    ds_read_b128 v[32:35], v152 offset:6144
    v_mfma_f32_16x16x32_bf16 v[128:131], v[52:55], v[228:231], v[128:131]
    ds_read_b128 v[36:39], v152 offset:20480
    v_mfma_f32_16x16x32_bf16 v[132:135], v[56:59], v[228:231], v[132:135]
    ds_read_b128 v[40:43], v152 offset:34816
    v_mfma_f32_16x16x32_bf16 v[136:139], v[60:63], v[228:231], v[136:139]
    ds_read_b128 v[44:47], v152 offset:49152
    s_waitcnt vmcnt(5) lgkmcnt(15)
    v_mfma_f32_16x16x32_bf16 v[124:127], v[64:67], v[232:235], v[124:127]
    ds_read_b128 v[48:51], v153 offset:6144
    v_mfma_f32_16x16x32_bf16 v[128:131], v[68:71], v[232:235], v[128:131]
    ds_read_b128 v[52:55], v153 offset:20480
    v_mfma_f32_16x16x32_bf16 v[132:135], v[72:75], v[232:235], v[132:135]
    ds_read_b128 v[56:59], v153 offset:34816
    v_mfma_f32_16x16x32_bf16 v[136:139], v[76:79], v[232:235], v[136:139]
    ds_read_b128 v[60:63], v153 offset:49152
    s_waitcnt vmcnt(4) lgkmcnt(15)
    global_load_dwordx2 v[14:15], v7, s[58:59] sc1
    global_load_dwordx2 v[16:17], v6, s[58:59] sc1
    global_load_dwordx2 v[18:19], v10, s[58:59] sc1
    global_load_dwordx2 v[20:21], v11, s[58:59] sc1
    global_load_dwordx2 v[22:23], v12, s[58:59] sc1
    v_mfma_f32_16x16x32_bf16 v[124:127], v[80:83], v[236:239], v[124:127]
    v_mfma_f32_16x16x32_bf16 v[128:131], v[84:87], v[236:239], v[128:131]
    v_mfma_f32_16x16x32_bf16 v[132:135], v[88:91], v[236:239], v[132:135]
    v_mfma_f32_16x16x32_bf16 v[136:139], v[92:95], v[236:239], v[136:139]
    s_waitcnt vmcnt(8) lgkmcnt(12)
    v_mfma_f32_16x16x32_bf16 v[124:127], v[140:143], v[240:243], v[124:127]
    v_mfma_f32_16x16x32_bf16 v[128:131], v[144:147], v[240:243], v[128:131]
    v_mfma_f32_16x16x32_bf16 v[132:135], v[148:151], v[240:243], v[132:135]
    v_mfma_f32_16x16x32_bf16 v[136:139], v[164:167], v[240:243], v[136:139]
    s_waitcnt vmcnt(7) lgkmcnt(8)
    v_mfma_f32_16x16x32_bf16 v[124:127], v[168:171], v[244:247], v[124:127]
    v_mfma_f32_16x16x32_bf16 v[128:131], v[172:175], v[244:247], v[128:131]
    v_mfma_f32_16x16x32_bf16 v[132:135], v[176:179], v[244:247], v[132:135]
    v_mfma_f32_16x16x32_bf16 v[136:139], v[180:183], v[244:247], v[136:139]
    s_waitcnt vmcnt(6) lgkmcnt(4)
    v_mfma_f32_16x16x32_bf16 v[124:127], v[32:35], v[248:251], v[124:127]
    v_mfma_f32_16x16x32_bf16 v[128:131], v[36:39], v[248:251], v[128:131]
    v_mfma_f32_16x16x32_bf16 v[132:135], v[40:43], v[248:251], v[132:135]
    v_mfma_f32_16x16x32_bf16 v[136:139], v[44:47], v[248:251], v[136:139]
    s_waitcnt vmcnt(5) lgkmcnt(0)
    v_mfma_f32_16x16x32_bf16 v[124:127], v[48:51], v[252:255], v[124:127]
    v_mfma_f32_16x16x32_bf16 v[128:131], v[52:55], v[252:255], v[128:131]
    v_mfma_f32_16x16x32_bf16 v[132:135], v[56:59], v[252:255], v[132:135]
    v_mfma_f32_16x16x32_bf16 v[136:139], v[60:63], v[252:255], v[136:139]
    s_cmp_eq_u32 s101, 0
    s_nop 6
    s_cbranch_scc1 LE0
    ds_write_b128 v5, v[124:127]
    ds_write_b128 v5, v[128:131] offset:1024
    v_pk_add_f32 v[192:193], v[132:133], v[192:193]
    v_pk_add_f32 v[194:195], v[134:135], v[194:195]
    v_pk_add_f32 v[196:197], v[136:137], v[196:197]
    v_pk_add_f32 v[198:199], v[138:139], v[198:199]
    s_nop 1
    s_branch LE1
LE0:
    ds_write_b128 v5, v[132:135]
    ds_write_b128 v5, v[136:139] offset:1024
    v_pk_add_f32 v[192:193], v[124:125], v[192:193]
    v_pk_add_f32 v[194:195], v[126:127], v[194:195]
    v_pk_add_f32 v[196:197], v[128:129], v[196:197]
    v_pk_add_f32 v[198:199], v[130:131], v[198:199]
    s_nop 1
LE1:
    s_waitcnt lgkmcnt(0)
    s_barrier
    ds_read_b128 v[40:43], v4
    ds_read_b128 v[44:47], v4 offset:1024
    s_mov_b32 s7, 0
    s_waitcnt vmcnt(0)
LTG3:
    v_xor_b32 v24, s31, v15
    v_xor_b32 v25, s31, v17
    v_or_b32 v24, v24, v25
    v_xor_b32 v25, s31, v19
    v_or_b32 v24, v24, v25
    v_xor_b32 v25, s31, v21
    v_or_b32 v24, v24, v25
    v_xor_b32 v25, s31, v23
    v_or_b32 v24, v24, v25
    v_cmp_ne_u32 vcc, 0, v24
    s_nop 4
    s_cbranch_vccz LTD3
    s_add_u32 s7, s7, 1
    s_cmp_gt_u32 s7, 0x40000
    s_cbranch_scc1 LTD3
    s_sleep 2
    global_load_dwordx2 v[14:15], v7, s[58:59] sc1
    global_load_dwordx2 v[16:17], v6, s[58:59] sc1
    global_load_dwordx2 v[18:19], v10, s[58:59] sc1
    global_load_dwordx2 v[20:21], v11, s[58:59] sc1
    global_load_dwordx2 v[22:23], v12, s[58:59] sc1
    s_waitcnt vmcnt(0)
    s_branch LTG3
LTD3:
    v_lshlrev_b32 v28, 16, v16
    v_and_b32 v29, 0xffff0000, v16
    v_lshlrev_b32 v30, 16, v18
    v_and_b32 v31, 0xffff0000, v18
    v_lshlrev_b32 v32, 16, v20
    v_and_b32 v33, 0xffff0000, v20
    v_lshlrev_b32 v34, 16, v22
    v_and_b32 v35, 0xffff0000, v22
    v_sub_f32 v15, 1.0, v14
    v_pk_add_f32 v[28:29], v[28:29], v[184:185]
    v_pk_add_f32 v[30:31], v[30:31], v[186:187]
    v_pk_add_f32 v[32:33], v[32:33], v[188:189]
    v_pk_add_f32 v[34:35], v[34:35], v[190:191]
    v_cvt_pk_bf16_f32 v15, v15, v15
    v_cvt_pk_bf16_f32 v16, v28, v29
    v_cvt_pk_bf16_f32 v17, v30, v31
    v_cvt_pk_bf16_f32 v18, v32, v33
    v_cvt_pk_bf16_f32 v19, v34, v35
    v_lshlrev_b32 v15, 16, v15
    v_lshlrev_b32 v28, 16, v16
    v_and_b32 v29, 0xffff0000, v16
    v_lshlrev_b32 v30, 16, v17
    v_and_b32 v31, 0xffff0000, v17
    v_lshlrev_b32 v32, 16, v18
    v_and_b32 v33, 0xffff0000, v18
    v_lshlrev_b32 v34, 16, v19
    v_and_b32 v35, 0xffff0000, v19
    v_pk_mul_f32 v[28:29], v[28:29], v[14:15] op_sel:[0,0] op_sel_hi:[1,0]
    v_pk_mul_f32 v[30:31], v[30:31], v[14:15] op_sel:[0,0] op_sel_hi:[1,0]
    v_pk_mul_f32 v[32:33], v[32:33], v[14:15] op_sel:[0,0] op_sel_hi:[1,0]
    v_pk_mul_f32 v[34:35], v[34:35], v[14:15] op_sel:[0,0] op_sel_hi:[1,0]
    v_cvt_pk_bf16_f32 v16, v28, v29
    v_cvt_pk_bf16_f32 v17, v30, v31
    v_cvt_pk_bf16_f32 v18, v32, v33
    v_cvt_pk_bf16_f32 v19, v34, v35
    s_waitcnt lgkmcnt(0)
    v_pk_add_f32 v[40:41], v[40:41], v[192:193]
    v_pk_add_f32 v[42:43], v[42:43], v[194:195]
    v_pk_add_f32 v[44:45], v[44:45], v[196:197]
    v_pk_add_f32 v[46:47], v[46:47], v[198:199]
    v_lshlrev_b32 v28, 16, v16
    v_and_b32 v29, 0xffff0000, v16
    v_lshlrev_b32 v30, 16, v17
    v_and_b32 v31, 0xffff0000, v17
    v_lshlrev_b32 v32, 16, v18
    v_and_b32 v33, 0xffff0000, v18
    v_lshlrev_b32 v34, 16, v19
    v_and_b32 v35, 0xffff0000, v19
    v_pk_fma_f32 v[28:29], v[40:41], v[14:15], v[28:29] op_sel:[0,1,0] op_sel_hi:[1,1,1]
    v_pk_fma_f32 v[30:31], v[42:43], v[14:15], v[30:31] op_sel:[0,1,0] op_sel_hi:[1,1,1]
    v_pk_fma_f32 v[32:33], v[44:45], v[14:15], v[32:33] op_sel:[0,1,0] op_sel_hi:[1,1,1]
    v_pk_fma_f32 v[34:35], v[46:47], v[14:15], v[34:35] op_sel:[0,1,0] op_sel_hi:[1,1,1]
    ds_write_b128 v96, v[28:31] offset:2048
    ds_write_b128 v96, v[32:35] offset:2064
    ds_read_b128 v[36:39], v100 offset:2048
    ds_read_b128 v[40:43], v100 offset:3200
    s_waitcnt lgkmcnt(1)
    global_store_dwordx4 v98, v[36:39], s[54:55] sc0 sc1
    s_waitcnt lgkmcnt(0)
    global_store_dwordx4 v99, v[40:43], s[54:55] sc0 sc1
    s_endpgm
LGATE:
    s_and_b32 s7, s2, 7
    s_lshl_b32 s7, s7, 2
    s_lshr_b32 s8, s2, 3
    s_add_u32 s5, s7, s8
    s_add_u32 s4, s5, 224
    s_lshl_b32 s7, s5, 6
    s_lshl_b32 s8, s3, 3
    s_add_u32 s9, s7, s8
    s_mul_i32 s7, s9, 896
    v_lshlrev_b32 v4, 4, v1
    v_add_u32 v5, s7, v4
    v_add_u32 v6, 3584, v5
    v_mov_b32 v60, 0
    v_mov_b32 v61, 0
    v_mov_b32 v62, 0
    v_mov_b32 v63, 0
    v_mov_b32 v64, 0
    v_mov_b32 v65, 0
    v_mov_b32 v66, 0
    v_mov_b32 v67, 0
    v_mov_b32 v68, 0
    v_mov_b32 v69, 0
    v_mov_b32 v70, 0
    v_mov_b32 v71, 0
    v_mov_b32 v72, 0
    v_mov_b32 v73, 0
    v_mov_b32 v74, 0
    v_mov_b32 v75, 0
    s_waitcnt lgkmcnt(0)
    s_load_dword s11, s[58:59], s12
    s_lshr_b32 s7, s2, 3
    s_lshl_b32 s7, s7, 3
    s_add_u32 s7, s7, s3
    s_mul_i32 s7, s7, 12544
    v_add_u32 v7, s7, v4
    s_mov_b32 exec_lo, -1
    s_mov_b32 exec_hi, 0xffffff
    global_load_dwordx4 v[8:11], v4, s[52:53]
    global_load_dwordx4 v[12:15], v5, s[16:17] offset:0
    global_load_dwordx4 v[16:19], v5, s[16:17] offset:896
    global_load_dwordx4 v[20:23], v5, s[16:17] offset:1792
    global_load_dwordx4 v[24:27], v5, s[16:17] offset:2688
    global_load_dwordx4 v[28:31], v6, s[16:17] offset:0
    global_load_dwordx4 v[32:35], v6, s[16:17] offset:896
    global_load_dwordx4 v[36:39], v6, s[16:17] offset:1792
    global_load_dwordx4 v[40:43], v6, s[16:17] offset:2688
    s_waitcnt vmcnt(0) lgkmcnt(0)
    s_add_u32 s31, s11, 0x9E3779B9
    v_lshlrev_b32 v44, 16, v8
    v_and_b32 v45, 0xffff0000, v8
    v_lshlrev_b32 v46, 16, v9
    v_and_b32 v47, 0xffff0000, v9
    v_lshlrev_b32 v48, 16, v10
    v_and_b32 v49, 0xffff0000, v10
    v_lshlrev_b32 v50, 16, v11
    v_and_b32 v51, 0xffff0000, v11
    v_lshlrev_b32 v52, 16, v12
    v_and_b32 v53, 0xffff0000, v12
    v_lshlrev_b32 v54, 16, v13
    v_and_b32 v55, 0xffff0000, v13
    v_lshlrev_b32 v56, 16, v14
    v_and_b32 v57, 0xffff0000, v14
    v_lshlrev_b32 v58, 16, v15
    v_and_b32 v59, 0xffff0000, v15
    v_pk_mul_f32 v[52:53], v[52:53], v[44:45]
    v_pk_mul_f32 v[54:55], v[54:55], v[46:47]
    v_pk_mul_f32 v[56:57], v[56:57], v[48:49]
    v_pk_mul_f32 v[58:59], v[58:59], v[50:51]
    v_cvt_pk_bf16_f32 v8, v52, v53
    v_cvt_pk_bf16_f32 v9, v54, v55
    v_cvt_pk_bf16_f32 v10, v56, v57
    v_cvt_pk_bf16_f32 v11, v58, v59
    v_lshlrev_b32 v52, 16, v8
    v_and_b32 v53, 0xffff0000, v8
    v_lshlrev_b32 v54, 16, v9
    v_and_b32 v55, 0xffff0000, v9
    v_lshlrev_b32 v56, 16, v10
    v_and_b32 v57, 0xffff0000, v10
    v_lshlrev_b32 v58, 16, v11
    v_and_b32 v59, 0xffff0000, v11
    v_pk_add_f32 v[60:61], v[60:61], v[52:53]
    v_pk_add_f32 v[60:61], v[60:61], v[54:55]
    v_pk_add_f32 v[60:61], v[60:61], v[56:57]
    v_pk_add_f32 v[60:61], v[60:61], v[58:59]
    v_lshlrev_b32 v52, 16, v16
    v_and_b32 v53, 0xffff0000, v16
    v_lshlrev_b32 v54, 16, v17
    v_and_b32 v55, 0xffff0000, v17
    v_lshlrev_b32 v56, 16, v18
    v_and_b32 v57, 0xffff0000, v18
    v_lshlrev_b32 v58, 16, v19
    v_and_b32 v59, 0xffff0000, v19
    v_pk_mul_f32 v[52:53], v[52:53], v[44:45]
    v_pk_mul_f32 v[54:55], v[54:55], v[46:47]
    v_pk_mul_f32 v[56:57], v[56:57], v[48:49]
    v_pk_mul_f32 v[58:59], v[58:59], v[50:51]
    v_cvt_pk_bf16_f32 v8, v52, v53
    v_cvt_pk_bf16_f32 v9, v54, v55
    v_cvt_pk_bf16_f32 v10, v56, v57
    v_cvt_pk_bf16_f32 v11, v58, v59
    v_lshlrev_b32 v52, 16, v8
    v_and_b32 v53, 0xffff0000, v8
    v_lshlrev_b32 v54, 16, v9
    v_and_b32 v55, 0xffff0000, v9
    v_lshlrev_b32 v56, 16, v10
    v_and_b32 v57, 0xffff0000, v10
    v_lshlrev_b32 v58, 16, v11
    v_and_b32 v59, 0xffff0000, v11
    v_pk_add_f32 v[62:63], v[62:63], v[52:53]
    v_pk_add_f32 v[62:63], v[62:63], v[54:55]
    v_pk_add_f32 v[62:63], v[62:63], v[56:57]
    v_pk_add_f32 v[62:63], v[62:63], v[58:59]
    v_lshlrev_b32 v52, 16, v20
    v_and_b32 v53, 0xffff0000, v20
    v_lshlrev_b32 v54, 16, v21
    v_and_b32 v55, 0xffff0000, v21
    v_lshlrev_b32 v56, 16, v22
    v_and_b32 v57, 0xffff0000, v22
    v_lshlrev_b32 v58, 16, v23
    v_and_b32 v59, 0xffff0000, v23
    v_pk_mul_f32 v[52:53], v[52:53], v[44:45]
    v_pk_mul_f32 v[54:55], v[54:55], v[46:47]
    v_pk_mul_f32 v[56:57], v[56:57], v[48:49]
    v_pk_mul_f32 v[58:59], v[58:59], v[50:51]
    v_cvt_pk_bf16_f32 v8, v52, v53
    v_cvt_pk_bf16_f32 v9, v54, v55
    v_cvt_pk_bf16_f32 v10, v56, v57
    v_cvt_pk_bf16_f32 v11, v58, v59
    v_lshlrev_b32 v52, 16, v8
    v_and_b32 v53, 0xffff0000, v8
    v_lshlrev_b32 v54, 16, v9
    v_and_b32 v55, 0xffff0000, v9
    v_lshlrev_b32 v56, 16, v10
    v_and_b32 v57, 0xffff0000, v10
    v_lshlrev_b32 v58, 16, v11
    v_and_b32 v59, 0xffff0000, v11
    v_pk_add_f32 v[64:65], v[64:65], v[52:53]
    v_pk_add_f32 v[64:65], v[64:65], v[54:55]
    v_pk_add_f32 v[64:65], v[64:65], v[56:57]
    v_pk_add_f32 v[64:65], v[64:65], v[58:59]
    v_lshlrev_b32 v52, 16, v24
    v_and_b32 v53, 0xffff0000, v24
    v_lshlrev_b32 v54, 16, v25
    v_and_b32 v55, 0xffff0000, v25
    v_lshlrev_b32 v56, 16, v26
    v_and_b32 v57, 0xffff0000, v26
    v_lshlrev_b32 v58, 16, v27
    v_and_b32 v59, 0xffff0000, v27
    v_pk_mul_f32 v[52:53], v[52:53], v[44:45]
    v_pk_mul_f32 v[54:55], v[54:55], v[46:47]
    v_pk_mul_f32 v[56:57], v[56:57], v[48:49]
    v_pk_mul_f32 v[58:59], v[58:59], v[50:51]
    v_cvt_pk_bf16_f32 v8, v52, v53
    v_cvt_pk_bf16_f32 v9, v54, v55
    v_cvt_pk_bf16_f32 v10, v56, v57
    v_cvt_pk_bf16_f32 v11, v58, v59
    v_lshlrev_b32 v52, 16, v8
    v_and_b32 v53, 0xffff0000, v8
    v_lshlrev_b32 v54, 16, v9
    v_and_b32 v55, 0xffff0000, v9
    v_lshlrev_b32 v56, 16, v10
    v_and_b32 v57, 0xffff0000, v10
    v_lshlrev_b32 v58, 16, v11
    v_and_b32 v59, 0xffff0000, v11
    v_pk_add_f32 v[66:67], v[66:67], v[52:53]
    v_pk_add_f32 v[66:67], v[66:67], v[54:55]
    v_pk_add_f32 v[66:67], v[66:67], v[56:57]
    v_pk_add_f32 v[66:67], v[66:67], v[58:59]
    v_lshlrev_b32 v52, 16, v28
    v_and_b32 v53, 0xffff0000, v28
    v_lshlrev_b32 v54, 16, v29
    v_and_b32 v55, 0xffff0000, v29
    v_lshlrev_b32 v56, 16, v30
    v_and_b32 v57, 0xffff0000, v30
    v_lshlrev_b32 v58, 16, v31
    v_and_b32 v59, 0xffff0000, v31
    v_pk_mul_f32 v[52:53], v[52:53], v[44:45]
    v_pk_mul_f32 v[54:55], v[54:55], v[46:47]
    v_pk_mul_f32 v[56:57], v[56:57], v[48:49]
    v_pk_mul_f32 v[58:59], v[58:59], v[50:51]
    v_cvt_pk_bf16_f32 v8, v52, v53
    v_cvt_pk_bf16_f32 v9, v54, v55
    v_cvt_pk_bf16_f32 v10, v56, v57
    v_cvt_pk_bf16_f32 v11, v58, v59
    v_lshlrev_b32 v52, 16, v8
    v_and_b32 v53, 0xffff0000, v8
    v_lshlrev_b32 v54, 16, v9
    v_and_b32 v55, 0xffff0000, v9
    v_lshlrev_b32 v56, 16, v10
    v_and_b32 v57, 0xffff0000, v10
    v_lshlrev_b32 v58, 16, v11
    v_and_b32 v59, 0xffff0000, v11
    v_pk_add_f32 v[68:69], v[68:69], v[52:53]
    v_pk_add_f32 v[68:69], v[68:69], v[54:55]
    v_pk_add_f32 v[68:69], v[68:69], v[56:57]
    v_pk_add_f32 v[68:69], v[68:69], v[58:59]
    v_lshlrev_b32 v52, 16, v32
    v_and_b32 v53, 0xffff0000, v32
    v_lshlrev_b32 v54, 16, v33
    v_and_b32 v55, 0xffff0000, v33
    v_lshlrev_b32 v56, 16, v34
    v_and_b32 v57, 0xffff0000, v34
    v_lshlrev_b32 v58, 16, v35
    v_and_b32 v59, 0xffff0000, v35
    v_pk_mul_f32 v[52:53], v[52:53], v[44:45]
    v_pk_mul_f32 v[54:55], v[54:55], v[46:47]
    v_pk_mul_f32 v[56:57], v[56:57], v[48:49]
    v_pk_mul_f32 v[58:59], v[58:59], v[50:51]
    v_cvt_pk_bf16_f32 v8, v52, v53
    v_cvt_pk_bf16_f32 v9, v54, v55
    v_cvt_pk_bf16_f32 v10, v56, v57
    v_cvt_pk_bf16_f32 v11, v58, v59
    v_lshlrev_b32 v52, 16, v8
    v_and_b32 v53, 0xffff0000, v8
    v_lshlrev_b32 v54, 16, v9
    v_and_b32 v55, 0xffff0000, v9
    v_lshlrev_b32 v56, 16, v10
    v_and_b32 v57, 0xffff0000, v10
    v_lshlrev_b32 v58, 16, v11
    v_and_b32 v59, 0xffff0000, v11
    v_pk_add_f32 v[70:71], v[70:71], v[52:53]
    v_pk_add_f32 v[70:71], v[70:71], v[54:55]
    v_pk_add_f32 v[70:71], v[70:71], v[56:57]
    v_pk_add_f32 v[70:71], v[70:71], v[58:59]
    v_lshlrev_b32 v52, 16, v36
    v_and_b32 v53, 0xffff0000, v36
    v_lshlrev_b32 v54, 16, v37
    v_and_b32 v55, 0xffff0000, v37
    v_lshlrev_b32 v56, 16, v38
    v_and_b32 v57, 0xffff0000, v38
    v_lshlrev_b32 v58, 16, v39
    v_and_b32 v59, 0xffff0000, v39
    v_pk_mul_f32 v[52:53], v[52:53], v[44:45]
    v_pk_mul_f32 v[54:55], v[54:55], v[46:47]
    v_pk_mul_f32 v[56:57], v[56:57], v[48:49]
    v_pk_mul_f32 v[58:59], v[58:59], v[50:51]
    v_cvt_pk_bf16_f32 v8, v52, v53
    v_cvt_pk_bf16_f32 v9, v54, v55
    v_cvt_pk_bf16_f32 v10, v56, v57
    v_cvt_pk_bf16_f32 v11, v58, v59
    v_lshlrev_b32 v52, 16, v8
    v_and_b32 v53, 0xffff0000, v8
    v_lshlrev_b32 v54, 16, v9
    v_and_b32 v55, 0xffff0000, v9
    v_lshlrev_b32 v56, 16, v10
    v_and_b32 v57, 0xffff0000, v10
    v_lshlrev_b32 v58, 16, v11
    v_and_b32 v59, 0xffff0000, v11
    v_pk_add_f32 v[72:73], v[72:73], v[52:53]
    v_pk_add_f32 v[72:73], v[72:73], v[54:55]
    v_pk_add_f32 v[72:73], v[72:73], v[56:57]
    v_pk_add_f32 v[72:73], v[72:73], v[58:59]
    v_lshlrev_b32 v52, 16, v40
    v_and_b32 v53, 0xffff0000, v40
    v_lshlrev_b32 v54, 16, v41
    v_and_b32 v55, 0xffff0000, v41
    v_lshlrev_b32 v56, 16, v42
    v_and_b32 v57, 0xffff0000, v42
    v_lshlrev_b32 v58, 16, v43
    v_and_b32 v59, 0xffff0000, v43
    v_pk_mul_f32 v[52:53], v[52:53], v[44:45]
    v_pk_mul_f32 v[54:55], v[54:55], v[46:47]
    v_pk_mul_f32 v[56:57], v[56:57], v[48:49]
    v_pk_mul_f32 v[58:59], v[58:59], v[50:51]
    v_cvt_pk_bf16_f32 v8, v52, v53
    v_cvt_pk_bf16_f32 v9, v54, v55
    v_cvt_pk_bf16_f32 v10, v56, v57
    v_cvt_pk_bf16_f32 v11, v58, v59
    v_lshlrev_b32 v52, 16, v8
    v_and_b32 v53, 0xffff0000, v8
    v_lshlrev_b32 v54, 16, v9
    v_and_b32 v55, 0xffff0000, v9
    v_lshlrev_b32 v56, 16, v10
    v_and_b32 v57, 0xffff0000, v10
    v_lshlrev_b32 v58, 16, v11
    v_and_b32 v59, 0xffff0000, v11
    v_pk_add_f32 v[74:75], v[74:75], v[52:53]
    v_pk_add_f32 v[74:75], v[74:75], v[54:55]
    v_pk_add_f32 v[74:75], v[74:75], v[56:57]
    v_pk_add_f32 v[74:75], v[74:75], v[58:59]
    s_mov_b64 exec, -1
    v_add_f32 v60, v60, v61
    v_add_f32 v62, v62, v63
    v_add_f32 v64, v64, v65
    v_add_f32 v66, v66, v67
    v_add_f32 v68, v68, v69
    v_add_f32 v70, v70, v71
    v_add_f32 v72, v72, v73
    v_add_f32 v74, v74, v75
    v_add_f32_dpp v60, v60, v60 row_shr:1 row_mask:0xf bank_mask:0xf
    v_add_f32_dpp v62, v62, v62 row_shr:1 row_mask:0xf bank_mask:0xf
    v_add_f32_dpp v64, v64, v64 row_shr:1 row_mask:0xf bank_mask:0xf
    v_add_f32_dpp v66, v66, v66 row_shr:1 row_mask:0xf bank_mask:0xf
    v_add_f32_dpp v68, v68, v68 row_shr:1 row_mask:0xf bank_mask:0xf
    v_add_f32_dpp v70, v70, v70 row_shr:1 row_mask:0xf bank_mask:0xf
    v_add_f32_dpp v72, v72, v72 row_shr:1 row_mask:0xf bank_mask:0xf
    v_add_f32_dpp v74, v74, v74 row_shr:1 row_mask:0xf bank_mask:0xf
    v_add_f32_dpp v60, v60, v60 row_shr:2 row_mask:0xf bank_mask:0xf
    v_add_f32_dpp v62, v62, v62 row_shr:2 row_mask:0xf bank_mask:0xf
    v_add_f32_dpp v64, v64, v64 row_shr:2 row_mask:0xf bank_mask:0xf
    v_add_f32_dpp v66, v66, v66 row_shr:2 row_mask:0xf bank_mask:0xf
    v_add_f32_dpp v68, v68, v68 row_shr:2 row_mask:0xf bank_mask:0xf
    v_add_f32_dpp v70, v70, v70 row_shr:2 row_mask:0xf bank_mask:0xf
    v_add_f32_dpp v72, v72, v72 row_shr:2 row_mask:0xf bank_mask:0xf
    v_add_f32_dpp v74, v74, v74 row_shr:2 row_mask:0xf bank_mask:0xf
    v_add_f32_dpp v60, v60, v60 row_shr:4 row_mask:0xf bank_mask:0xf
    v_add_f32_dpp v62, v62, v62 row_shr:4 row_mask:0xf bank_mask:0xf
    v_add_f32_dpp v64, v64, v64 row_shr:4 row_mask:0xf bank_mask:0xf
    v_add_f32_dpp v66, v66, v66 row_shr:4 row_mask:0xf bank_mask:0xf
    v_add_f32_dpp v68, v68, v68 row_shr:4 row_mask:0xf bank_mask:0xf
    v_add_f32_dpp v70, v70, v70 row_shr:4 row_mask:0xf bank_mask:0xf
    v_add_f32_dpp v72, v72, v72 row_shr:4 row_mask:0xf bank_mask:0xf
    v_add_f32_dpp v74, v74, v74 row_shr:4 row_mask:0xf bank_mask:0xf
    v_add_f32_dpp v60, v60, v60 row_shr:8 row_mask:0xf bank_mask:0xf
    v_add_f32_dpp v62, v62, v62 row_shr:8 row_mask:0xf bank_mask:0xf
    v_add_f32_dpp v64, v64, v64 row_shr:8 row_mask:0xf bank_mask:0xf
    v_add_f32_dpp v66, v66, v66 row_shr:8 row_mask:0xf bank_mask:0xf
    v_add_f32_dpp v68, v68, v68 row_shr:8 row_mask:0xf bank_mask:0xf
    v_add_f32_dpp v70, v70, v70 row_shr:8 row_mask:0xf bank_mask:0xf
    v_add_f32_dpp v72, v72, v72 row_shr:8 row_mask:0xf bank_mask:0xf
    v_add_f32_dpp v74, v74, v74 row_shr:8 row_mask:0xf bank_mask:0xf
    v_add_f32_dpp v60, v60, v60 row_bcast:15 row_mask:0xa bank_mask:0xf
    v_add_f32_dpp v62, v62, v62 row_bcast:15 row_mask:0xa bank_mask:0xf
    v_add_f32_dpp v64, v64, v64 row_bcast:15 row_mask:0xa bank_mask:0xf
    v_add_f32_dpp v66, v66, v66 row_bcast:15 row_mask:0xa bank_mask:0xf
    v_add_f32_dpp v68, v68, v68 row_bcast:15 row_mask:0xa bank_mask:0xf
    v_add_f32_dpp v70, v70, v70 row_bcast:15 row_mask:0xa bank_mask:0xf
    v_add_f32_dpp v72, v72, v72 row_bcast:15 row_mask:0xa bank_mask:0xf
    v_add_f32_dpp v74, v74, v74 row_bcast:15 row_mask:0xa bank_mask:0xf
    v_add_f32_dpp v60, v60, v60 row_bcast:31 row_mask:0xc bank_mask:0xf
    v_add_f32_dpp v62, v62, v62 row_bcast:31 row_mask:0xc bank_mask:0xf
    v_add_f32_dpp v64, v64, v64 row_bcast:31 row_mask:0xc bank_mask:0xf
    v_add_f32_dpp v66, v66, v66 row_bcast:31 row_mask:0xc bank_mask:0xf
    v_add_f32_dpp v68, v68, v68 row_bcast:31 row_mask:0xc bank_mask:0xf
    v_add_f32_dpp v70, v70, v70 row_bcast:31 row_mask:0xc bank_mask:0xf
    v_add_f32_dpp v72, v72, v72 row_bcast:31 row_mask:0xc bank_mask:0xf
    v_add_f32_dpp v74, v74, v74 row_bcast:31 row_mask:0xc bank_mask:0xf
    v_readlane_b32 s64, v60, 63
    v_readlane_b32 s65, v62, 63
    v_readlane_b32 s66, v64, 63
    v_readlane_b32 s67, v66, 63
    v_readlane_b32 s68, v68, 63
    v_readlane_b32 s69, v70, 63
    v_readlane_b32 s70, v72, 63
    v_readlane_b32 s71, v74, 63
    v_writelane_b32 v8, s64, 0
    v_writelane_b32 v8, s65, 1
    v_writelane_b32 v8, s66, 2
    v_writelane_b32 v8, s67, 3
    v_writelane_b32 v8, s68, 4
    v_writelane_b32 v8, s69, 5
    v_writelane_b32 v8, s70, 6
    v_writelane_b32 v8, s71, 7
    v_cvt_pk_bf16_f32 v8, v8, v8
    v_lshlrev_b32 v8, 16, v8
    v_mul_f32 v8, 0xbfb8aa3b, v8
    v_exp_f32 v8, v8
    s_nop 0
    v_add_f32 v8, 1.0, v8
    v_rcp_f32 v8, v8
    s_lshl_b32 s7, s9, 3
    s_add_u32 s7, s7, 12582912
    v_cvt_pk_bf16_f32 v8, v8, v8
    v_lshlrev_b32 v8, 16, v8
    v_mov_b32 v9, s31
    v_lshl_add_u32 v10, v1, 3, s7
    s_mov_b64 exec, 0xff
    global_store_dwordx2 v10, v[8:9], s[58:59] sc1
    s_mov_b64 exec, -1
    global_load_dwordx4 v[140:143], v7, s[44:45] offset:0
    global_load_dwordx4 v[144:147], v7, s[46:47] offset:0
    global_load_dwordx4 v[148:151], v7, s[44:45] offset:1024
    global_load_dwordx4 v[152:155], v7, s[46:47] offset:1024
    global_load_dwordx4 v[156:159], v7, s[44:45] offset:2048
    global_load_dwordx4 v[160:163], v7, s[46:47] offset:2048
    global_load_dwordx4 v[164:167], v7, s[44:45] offset:3072
    global_load_dwordx4 v[168:171], v7, s[46:47] offset:3072
    v_add_u32 v7, 4096, v7
    global_load_dwordx4 v[172:175], v7, s[44:45] offset:0
    global_load_dwordx4 v[176:179], v7, s[46:47] offset:0
    global_load_dwordx4 v[180:183], v7, s[44:45] offset:1024
    global_load_dwordx4 v[184:187], v7, s[46:47] offset:1024
    global_load_dwordx4 v[188:191], v7, s[44:45] offset:2048
    global_load_dwordx4 v[192:195], v7, s[46:47] offset:2048
    global_load_dwordx4 v[196:199], v7, s[44:45] offset:3072
    global_load_dwordx4 v[200:203], v7, s[46:47] offset:3072
    v_add_u32 v7, 4096, v7
    global_load_dwordx4 v[204:207], v7, s[44:45] offset:0
    global_load_dwordx4 v[208:211], v7, s[46:47] offset:0
    global_load_dwordx4 v[212:215], v7, s[44:45] offset:1024
    global_load_dwordx4 v[216:219], v7, s[46:47] offset:1024
    global_load_dwordx4 v[220:223], v7, s[44:45] offset:2048
    global_load_dwordx4 v[224:227], v7, s[46:47] offset:2048
    global_load_dwordx4 v[228:231], v7, s[44:45] offset:3072
    global_load_dwordx4 v[232:235], v7, s[46:47] offset:3072
    s_mov_b64 exec, 0xffff
    v_add_u32 v7, 4096, v7
    global_load_dwordx4 v[236:239], v7, s[44:45] offset:0
    global_load_dwordx4 v[240:243], v7, s[46:47] offset:0
    s_mov_b64 exec, -1
    s_cmp_lg_u32 s2, 0
    s_cbranch_scc1 LEND
    v_min_u32 v4, 479, v0
    v_lshlrev_b32 v5, 7, v4
    v_add_u32 v5, 12648448, v5
    v_lshlrev_b32 v6, 6, v4
    v_add_u32 v6, 12568580, v6
    v_cmp_gt_u32 vcc, 224, v4
    s_nop 1
    v_cndmask_b32 v5, v6, v5, vcc
    s_sleep 32
    global_load_dword v8, v5, s[58:59] sc1
    s_mov_b32 s7, 0
    s_waitcnt vmcnt(0)
LTG4:
    v_xor_b32 v12, s31, v8
    v_cmp_ne_u32 vcc, 0, v12
    s_nop 4
    s_cbranch_vccz LTD4
    s_add_u32 s7, s7, 1
    s_cmp_gt_u32 s7, 0x40000
    s_cbranch_scc1 LTD4
    s_sleep 2
    s_sleep 32
    global_load_dword v8, v5, s[58:59] sc1
    s_waitcnt vmcnt(0)
    s_branch LTG4
LTD4:
    s_barrier
    s_cmp_lg_u32 s3, 0
    s_cbranch_scc1 LEND
    v_mov_b32 v4, 12713984
    s_mov_b64 exec, 1
    global_store_dword v4, v9, s[58:59] sc1
LEND:
    s_endpgm
.section .rodata,"a"
.p2align 6
.amdhsa_kernel gated_mix__ssm_conv_s4__ssm_conv_s5__prompt_kernel
  .amdhsa_next_free_vgpr 256
  .amdhsa_next_free_sgpr 102
  .amdhsa_accum_offset 256
  .amdhsa_group_segment_fixed_size 0
  .amdhsa_kernarg_size 176
  .amdhsa_user_sgpr_count 2
  .amdhsa_user_sgpr_kernarg_segment_ptr 1
  .amdhsa_system_sgpr_workgroup_id_x 1
.end_amdhsa_kernel
```
